```python
import torch

def _softmax(x, axis=-1):
    return torch.softmax(x, dim=axis)

def _gelu(x):
    return torch.nn.functional.gelu(x, approximate='tanh')

def _silu(x):
    return torch.nn.functional.silu(x)

def _sigmoid(x):
    return torch.sigmoid(x)

def _layernorm(x, axis=-1, eps=1e-05):
    m = x.mean(dim=axis, keepdim=True)
    v = x.var(dim=axis, keepdim=True, unbiased=False)
    return (x - m) / torch.sqrt(v + eps)

def _scatter_add(tgt, idx, src, axis=0):
    return tgt.clone().index_add_(axis, idx, src)

def _segment_sum(src, seg, n):
    out = torch.zeros((n,) + src.shape[1:], dtype=src.dtype)
    return out.index_add_(0, seg, src)

def _pad(x, pw):
    flat = tuple((v for pair in reversed(pw) for v in pair))
    return torch.nn.functional.pad(x, flat)
kernel_name = 'adaLN_cond__sliding_block_cached__glu_gated_glu__decode'

def setup_inputs():

    _w = lambda a: (lambda t: t.to(torch.bfloat16) if t.is_floating_point() else t)(torch.as_tensor(a))

    def _A_setup():
        B, Sq, D = (8, 1, 448)
        Hq, Hkv, Sk, Dh = (16, 8, 8192, 256)
        assert Hq % Hkv == 0, (Hq, Hkv)
        return {'x': _w((lambda *s: torch.randn(*s, dtype=torch.bfloat16) * 0.05)(B, Sq, D)), 'k_cache': _w((lambda *s: torch.randn(*s, dtype=torch.bfloat16) * 3.2)(B, Hkv, Sk, Dh)), 'v_cache': _w((lambda *s: torch.randn(*s, dtype=torch.bfloat16) * 0.4)(B, Hkv, Sk, Dh)), 'wq': _w((lambda *s: torch.randn(*s, dtype=torch.bfloat16) * 3.2)(D, Hq * Dh) * D ** (-0.5)), 'wo': _w((lambda *s: torch.randn(*s, dtype=torch.bfloat16) * 0.4)(Hq * Dh, D) * (Hq * Dh) ** (-0.5))}
    _A_in = _A_setup()

    def _B_setup():
        B, S, D, F = (8, 1, 448, 1792)
        return {'x': _w((lambda *s: torch.randn(*s, dtype=torch.bfloat16) * 0.05)(B, S, D)), 'w_gate': _w((lambda *s: torch.randn(*s, dtype=torch.bfloat16) * 0.05)(D, F)), 'w_up': _w((lambda *s: torch.randn(*s, dtype=torch.bfloat16) * 0.05)(D, F)), 'w_down': _w((lambda *s: torch.randn(*s, dtype=torch.bfloat16) * 0.05)(F, D))}
    _B_in = _B_setup()
    return {'A_x': _A_in['x'], 'A_k_cache': _A_in['k_cache'], 'A_v_cache': _A_in['v_cache'], 'A_wq': _A_in['wq'], 'A_wo': _A_in['wo'], 'B_x': _B_in['x'], 'B_w_gate': _B_in['w_gate'], 'B_w_up': _B_in['w_up'], 'B_w_down': _B_in['w_down'], 'c': _w((lambda *s: torch.randn(*s, dtype=torch.bfloat16) * 0.1)(8, 448) * 8.0), 'w_mod': _w((lambda *s: torch.randn(*s, dtype=torch.bfloat16) * 0.1)(448, 6 * 448) * 448 ** (-0.5) * 8.0)}

def reference(A_x, A_k_cache, A_v_cache, A_wq, A_wo, B_x, B_w_gate, B_w_up, B_w_down, c, w_mod):

    def _A_ref(x, k_cache, v_cache, wq, wo):
        B, Sq, D = x.shape
        Hq, Dh = (16, 256)
        Hkv, Sk = (k_cache.shape[1], k_cache.shape[2])
        W = min(4096, max(256, Sk // 4))
        rep = Hq // Hkv
        q = (lambda x, *d: x.permute(*d))((x @ wq).reshape(B, Sq, Hq, Dh), 0, 2, 1, 3)
        k = (lambda x, n, axis: torch.repeat_interleave(x, n, dim=axis))(k_cache[:, :, Sk - W:, :], rep, axis=1)
        v = (lambda x, n, axis: torch.repeat_interleave(x, n, dim=axis))(v_cache[:, :, Sk - W:, :], rep, axis=1)
        scores = torch.einsum('bhqd,bhkd->bhqk', q, k) * Dh ** (-0.5)
        p = _softmax(scores, axis=-1)
        o = torch.einsum('bhqk,bhkd->bhqd', p, v)
        return (lambda x, *d: x.permute(*d))(o, 0, 2, 1, 3).reshape(B, Sq, Hq * Dh) @ wo

    def _B_ref(x, w_gate, w_up, w_down):
        g = torch.einsum('bsd,df->bsf', x, w_gate)
        u = torch.einsum('bsd,df->bsf', x, w_up)
        h = _sigmoid(g) * u
        return torch.einsum('bsf,fd->bsd', h, w_down)
    x = A_x
    mod = (_silu(c) @ w_mod).reshape(c.shape[0], 6, 1, -1)
    sa, ca, ga, sb, cb, gb = (mod[:, 0].clone(), mod[:, 1].clone(), mod[:, 2].clone(), mod[:, 3].clone(), mod[:, 4].clone(), mod[:, 5].clone())
    h = _layernorm(x, axis=-1) * (1 + ca) + sa
    x = x + ga * _A_ref(h, A_k_cache, A_v_cache, A_wq, A_wo)
    h = _layernorm(x, axis=-1) * (1 + cb) + sb
    x = x + gb * _B_ref(h, B_w_gate, B_w_up, B_w_down)
    return x
```

```asm
; @launch grid=(256,1,1) block=(512,1,1) lds=163840
.amdgcn_target "amdgcn-amd-amdhsa--gfx950"
.text
.globl adaLN_cond__sliding_block_cached__glu_gated_glu__decode_kernel
.p2align 8
.type adaLN_cond__sliding_block_cached__glu_gated_glu__decode_kernel,@function
adaLN_cond__sliding_block_cached__glu_gated_glu__decode_kernel:
L_start:
  s_cmp_ge_u32 s2, 256
  s_cbranch_scc1 L_end
  s_load_dwordx16 s[16:31], s[0:1], 0
  s_load_dwordx8 s[32:39], s[0:1], 64
  s_load_dwordx4 s[40:43], s[0:1], 96
  v_lshrrev_b32 v2, 6, v0
  v_and_b32 v1, 63, v0
  v_readfirstlane_b32 s3, v2
  s_lshr_b32 s4, s2, 5
  s_bfe_u32 s5, s2, 0x20003
  s_and_b32 s6, s2, 7
  s_mov_b32 s9, 0
  s_mov_b32 s10, s6
  s_mov_b32 s12, 0
  s_mov_b32 s47, 28
  s_bitcmp1_b32 s4, 0
  s_cbranch_scc1 L_odd
  s_cmp_eq_u32 s5, 3
  s_cselect_b32 s12, 1, 0
  s_cmp_lg_u32 s5, 0
  s_cbranch_scc1 L_roled
  s_lshl_b32 s10, s4, 2
  s_add_u32 s10, s10, s6
  s_cmp_lt_u32 s10, 10
  s_cselect_b32 s9, 3, 0
  s_branch L_roled
L_odd:
  s_mul_i32 s47, s6, 3
  s_add_u32 s47, s47, s5
  s_cmp_lg_u32 s5, 3
  s_cbranch_scc1 L_roled
  s_lshr_b32 s47, s6, 1
  s_add_u32 s47, s47, 24
  s_and_b32 s13, s6, 1
  s_lshr_b32 s14, s4, 2
  s_cmp_eq_u32 s13, s14
  s_cbranch_scc1 L_roled
  s_mov_b32 s47, 28
  s_mov_b32 s9, 2
  s_bitcmp1_b32 s4, 1
  s_cbranch_scc1 L_roled
  s_cmp_lt_u32 s6, 7
  s_cselect_b32 s9, 1, 2
  s_cselect_b32 s10, s6, 8
L_roled:
  s_and_b32 s8, s3, 3
  s_add_u32 s7, s6, 0
  s_and_b32 s7, s7, 7
  s_mov_b32 s46, 0xffff0000
  s_mov_b32 s84, 0x20000
  s_cmp_ge_u32 s3, 4
  s_cbranch_scc1 L_helper
  v_bfe_u32 v2, v1, 3, 1
  v_lshlrev_b32 v2, 9, v2
  v_and_b32 v3, 7, v1
  v_lshl_add_u32 v2, v3, 4, v2
  v_lshrrev_b32 v3, 4, v1
  v_lshl_add_u32 v2, v3, 7, v2
  s_lshl_b32 s68, s4, 3
  s_add_u32 s68, s68, s7
  s_lshl_b32 s68, s68, 22
  s_lshl_b32 s69, s5, 18
  s_add_u32 s68, s68, s69
  s_add_u32 s68, s68, 3145728
  s_mul_i32 s70, s2, 4096
  s_lshl_b32 s69, s3, 12
  s_add_u32 s70, s70, s69
  s_and_b32 s70, s70, 0x3ffff
  s_mov_b32 s71, s70
  s_mov_b32 s54, 0x40000
  s_mov_b32 s55, 0x20000
  s_waitcnt lgkmcnt(0)
  s_add_u32 s52, s18, s68
  s_addc_u32 s53, s19, 0
  buffer_load_dwordx4 v[32:35], v2, s[52:55], s70 offen offset:0 nt
  buffer_load_dwordx4 v[36:39], v2, s[52:55], s70 offen offset:1024 nt
  buffer_load_dwordx4 v[40:43], v2, s[52:55], s70 offen offset:2048 nt
  buffer_load_dwordx4 v[44:47], v2, s[52:55], s70 offen offset:3072 nt
  s_add_u32 s70, s70, 16384
  s_and_b32 s70, s70, 0x3ffff
  buffer_load_dwordx4 v[48:51], v2, s[52:55], s70 offen offset:0 nt
  buffer_load_dwordx4 v[52:55], v2, s[52:55], s70 offen offset:1024 nt
  buffer_load_dwordx4 v[56:59], v2, s[52:55], s70 offen offset:2048 nt
  buffer_load_dwordx4 v[60:63], v2, s[52:55], s70 offen offset:3072 nt
  s_add_u32 s70, s70, 16384
  s_and_b32 s70, s70, 0x3ffff
  s_barrier
L_nob0:
  s_add_u32 s56, s20, s68
  s_addc_u32 s57, s21, 0
  s_mov_b32 s58, 0x40000
  s_mov_b32 s59, 0x20000
  v_and_b32 v4, 1, v3
  v_lshlrev_b32 v4, 10, v4
  v_lshrrev_b32 v5, 1, v3
  v_lshl_add_u32 v4, v5, 9, v4
  v_and_b32 v5, 15, v1
  v_lshl_add_u32 v3, v5, 4, v4
  v_and_b32 v4, 1, v1
  v_lshlrev_b32 v4, 4, v4
  v_mov_b32 v5, 0xffff
  v_lshlrev_b32 v4, v4, v5
  v_bfe_u32 v5, v1, 1, 2
  v_cmp_eq_u32 vcc, 0, v5
  s_nop 1
  v_cndmask_b32 v16, 0, v4, vcc
  v_cmp_eq_u32 vcc, 1, v5
  s_nop 1
  v_cndmask_b32 v17, 0, v4, vcc
  v_cmp_eq_u32 vcc, 2, v5
  s_nop 1
  v_cndmask_b32 v18, 0, v4, vcc
  v_cmp_eq_u32 vcc, 3, v5
  s_nop 1
  v_cndmask_b32 v19, 0, v4, vcc
  v_lshrrev_b32 v4, 4, v1
  s_cmp_lt_u32 s47, 28
  s_cbranch_scc1 L_mwfs
  v_mul_u32_u24 v4, 14336, v4
  s_cmp_eq_u32 s5, 3
  s_cselect_b32 s13, 7, 15
  v_and_b32 v5, s13, v1
  v_lshl_add_u32 v4, v5, 4, v4
  s_lshl_b32 s13, s6, 3
  s_add_u32 s13, s13, s8
  s_add_u32 s13, s13, 4
  s_mul_i32 s13, s13, 57344
  s_lshl_b32 s14, s5, 8
  s_add_u32 s13, s13, s14
  s_bitcmp0_b32 s4, 0
  s_cselect_b32 s72, 896, 0
  s_cselect_b32 s14, -1, 0
  v_and_b32 v4, s14, v4
  v_mov_b32 v6, s24
  v_mov_b32 v7, s25
  s_branch L_mwjs
L_mwfs:
  v_mul_u32_u24 v4, 3584, v4
  v_and_b32 v5, 7, v1
  v_lshl_add_u32 v4, v5, 4, v4
  s_mul_i32 s13, s8, 229376
  s_lshl_b32 s14, s47, 7
  s_add_u32 s13, s13, s14
  s_movk_i32 s72, 14336
  s_mov_b32 vcc_lo, 0xff00ff00
  s_mov_b32 vcc_hi, 0xff00ff00
  v_mov_b32 v5, s28
  v_mov_b32 v6, s30
  v_cndmask_b32 v6, v5, v6, vcc
  v_mov_b32 v5, s29
  v_mov_b32 v7, s31
  v_cndmask_b32 v7, v5, v7, vcc
L_mwjs:
  v_add_u32 v4, s13, v4
  v_add_co_u32 v28, vcc, v6, v4
  s_nop 1
  v_addc_co_u32 v29, vcc, 0, v7, vcc
  s_mov_b32 s48, s42
  s_mov_b32 s49, s43
  s_mov_b32 s50, 3145728
  s_mov_b32 s51, 0x20000
  s_mov_b32 s80, 0xcccccccc
  s_mov_b32 s81, 0xcccccccc
  s_mov_b32 s82, 0xf0f0f0f0
  s_mov_b32 s83, 0xf0f0f0f0
  v_lshlrev_b32 v31, 4, v1
  s_mul_i32 s85, s3, 32768
  s_add_u32 s85, s85, 32768
  v_add_u32 v30, s85, v31
  s_sub_u32 s85, s85, 4096
  s_mov_b32 s13, 0
  s_or_b32 s13, s13, s12
  s_or_b32 s13, s13, s9
  s_and_b32 s14, s47, 3
  s_cmp_eq_u32 s14, 3
  s_cselect_b32 s14, 1, 0
  s_or_b32 s13, s13, s14
  s_mov_b32 vcc_lo, s13
  s_mov_b32 vcc_hi, 0
  s_waitcnt vmcnt(7)
  buffer_load_dwordx4 v[64:67], v2, s[52:55], s70 offen offset:0 nt
  s_waitcnt vmcnt(7)
  buffer_load_dwordx4 v[68:71], v2, s[52:55], s70 offen offset:1024 nt
  s_waitcnt vmcnt(7)
  buffer_load_dwordx4 v[72:75], v2, s[52:55], s70 offen offset:2048 nt
  s_waitcnt vmcnt(7)
  buffer_load_dwordx4 v[76:79], v2, s[52:55], s70 offen offset:3072 nt
  s_add_u32 s70, s70, 16384
  s_and_b32 s70, s70, 0x3ffff
  s_waitcnt vmcnt(7)
  buffer_load_dwordx4 v[80:83], v2, s[52:55], s70 offen offset:0 nt
  s_waitcnt vmcnt(7)
  buffer_load_dwordx4 v[84:87], v2, s[52:55], s70 offen offset:1024 nt
  s_waitcnt vmcnt(7)
  buffer_load_dwordx4 v[88:91], v2, s[52:55], s70 offen offset:2048 nt
  s_waitcnt vmcnt(7)
  buffer_load_dwordx4 v[92:95], v2, s[52:55], s70 offen offset:3072 nt
  s_add_u32 s70, s70, 16384
  s_and_b32 s70, s70, 0x3ffff
  s_waitcnt vmcnt(7)
  buffer_load_dwordx4 v[96:99], v2, s[52:55], s70 offen offset:0 nt
  s_waitcnt vmcnt(7)
  buffer_load_dwordx4 v[100:103], v2, s[52:55], s70 offen offset:1024 nt
  s_waitcnt vmcnt(7)
  buffer_load_dwordx4 v[104:107], v2, s[52:55], s70 offen offset:2048 nt
  s_waitcnt vmcnt(7)
  buffer_load_dwordx4 v[108:111], v2, s[52:55], s70 offen offset:3072 nt
  s_add_u32 s70, s70, 16384
  s_and_b32 s70, s70, 0x3ffff
  s_waitcnt vmcnt(7)
  buffer_load_dwordx4 v[112:115], v2, s[52:55], s70 offen offset:0 nt
  s_waitcnt vmcnt(7)
  buffer_load_dwordx4 v[116:119], v2, s[52:55], s70 offen offset:1024 nt
  s_waitcnt vmcnt(7)
  buffer_load_dwordx4 v[120:123], v2, s[52:55], s70 offen offset:2048 nt
  s_waitcnt vmcnt(7)
  buffer_load_dwordx4 v[124:127], v2, s[52:55], s70 offen offset:3072 nt
  s_add_u32 s70, s70, 16384
  s_and_b32 s70, s70, 0x3ffff
  s_waitcnt vmcnt(7)
  buffer_load_dwordx4 v[128:131], v2, s[52:55], s70 offen offset:0 nt
  s_waitcnt vmcnt(7)
  buffer_load_dwordx4 v[132:135], v2, s[52:55], s70 offen offset:1024 nt
  s_waitcnt vmcnt(7)
  buffer_load_dwordx4 v[136:139], v2, s[52:55], s70 offen offset:2048 nt
  s_waitcnt vmcnt(7)
  buffer_load_dwordx4 v[140:143], v2, s[52:55], s70 offen offset:3072 nt
  s_add_u32 s70, s70, 16384
  s_and_b32 s70, s70, 0x3ffff
  s_waitcnt vmcnt(7)
  buffer_load_dwordx4 v[144:147], v2, s[52:55], s70 offen offset:0 nt
  s_waitcnt vmcnt(7)
  buffer_load_dwordx4 v[148:151], v2, s[52:55], s70 offen offset:1024 nt
  s_waitcnt vmcnt(7)
  buffer_load_dwordx4 v[152:155], v2, s[52:55], s70 offen offset:2048 nt
  s_waitcnt vmcnt(7)
  buffer_load_dwordx4 v[156:159], v2, s[52:55], s70 offen offset:3072 nt
  s_add_u32 s70, s70, 16384
  s_and_b32 s70, s70, 0x3ffff
  s_waitcnt vmcnt(7)
  buffer_load_dwordx4 v[160:163], v2, s[52:55], s70 offen offset:0 nt
  s_waitcnt vmcnt(7)
  buffer_load_dwordx4 v[164:167], v2, s[52:55], s70 offen offset:1024 nt
  s_waitcnt vmcnt(7)
  buffer_load_dwordx4 v[168:171], v2, s[52:55], s70 offen offset:2048 nt
  s_waitcnt vmcnt(7)
  buffer_load_dwordx4 v[172:175], v2, s[52:55], s70 offen offset:3072 nt
  s_add_u32 s70, s70, 16384
  s_and_b32 s70, s70, 0x3ffff
  s_waitcnt vmcnt(7)
  buffer_load_dwordx4 v[176:179], v2, s[52:55], s70 offen offset:0 nt
  s_waitcnt vmcnt(7)
  buffer_load_dwordx4 v[180:183], v2, s[52:55], s70 offen offset:1024 nt
  s_waitcnt vmcnt(7)
  buffer_load_dwordx4 v[184:187], v2, s[52:55], s70 offen offset:2048 nt
  s_waitcnt vmcnt(7)
  buffer_load_dwordx4 v[188:191], v2, s[52:55], s70 offen offset:3072 nt
  s_add_u32 s70, s70, 16384
  s_and_b32 s70, s70, 0x3ffff
  s_waitcnt vmcnt(7)
  buffer_load_dwordx4 v[192:195], v2, s[52:55], s70 offen offset:0 nt
  s_waitcnt vmcnt(7)
  buffer_load_dwordx4 v[196:199], v2, s[52:55], s70 offen offset:1024 nt
  s_waitcnt vmcnt(7)
  buffer_load_dwordx4 v[200:203], v2, s[52:55], s70 offen offset:2048 nt
  s_waitcnt vmcnt(7)
  buffer_load_dwordx4 v[204:207], v2, s[52:55], s70 offen offset:3072 nt
  s_add_u32 s70, s70, 16384
  s_and_b32 s70, s70, 0x3ffff
  s_waitcnt vmcnt(7)
  buffer_load_dwordx4 v[208:211], v2, s[52:55], s70 offen offset:0 nt
  s_waitcnt vmcnt(7)
  buffer_load_dwordx4 v[212:215], v2, s[52:55], s70 offen offset:1024 nt
  s_waitcnt vmcnt(7)
  buffer_load_dwordx4 v[216:219], v2, s[52:55], s70 offen offset:2048 nt
  s_waitcnt vmcnt(7)
  buffer_load_dwordx4 v[220:223], v2, s[52:55], s70 offen offset:3072 nt
  s_add_u32 s70, s70, 16384
  s_and_b32 s70, s70, 0x3ffff
  s_waitcnt vmcnt(7)
  buffer_load_dwordx4 v[224:227], v2, s[52:55], s70 offen offset:0 nt
  s_waitcnt vmcnt(7)
  buffer_load_dwordx4 v[228:231], v2, s[52:55], s70 offen offset:1024 nt
  s_waitcnt vmcnt(7)
  buffer_load_dwordx4 v[232:235], v2, s[52:55], s70 offen offset:2048 nt
  s_waitcnt vmcnt(7)
  buffer_load_dwordx4 v[236:239], v2, s[52:55], s70 offen offset:3072 nt
  s_add_u32 s70, s70, 16384
  s_and_b32 s70, s70, 0x3ffff
  s_waitcnt vmcnt(7)
  buffer_load_dwordx4 v[240:243], v2, s[52:55], s70 offen offset:0 nt
  s_waitcnt vmcnt(7)
  buffer_load_dwordx4 v[244:247], v2, s[52:55], s70 offen offset:1024 nt
  s_waitcnt vmcnt(7)
  buffer_load_dwordx4 v[248:251], v2, s[52:55], s70 offen offset:2048 nt
  s_waitcnt vmcnt(7)
  buffer_load_dwordx4 v[252:255], v2, s[52:55], s70 offen offset:3072 nt
  s_add_u32 s70, s70, 16384
  s_and_b32 s70, s70, 0x3ffff
  s_or_b32 s13, s9, s12
  s_cbranch_scc0 L_stagefree
  v_mov_b32 v4, 0
L_spinS:
  ds_read_b32 v5, v4 offset:16
  s_waitcnt lgkmcnt(0)
  v_readfirstlane_b32 s13, v5
  s_nop 0
  s_cmp_ge_u32 s13, 4
  s_cbranch_scc1 L_spunS
  s_sub_u32 s84, s84, 1
  s_cbranch_scc1 L_fin
  s_branch L_spinS
L_spunS:
L_stagefree:
  s_waitcnt vmcnt(7)
  s_add_u32 m0, s85, 4096
  s_nop 0
  buffer_load_dwordx4 v2, s[52:55], s70 offen offset:0 nt lds
  s_waitcnt vmcnt(7)
  s_add_u32 m0, s85, 4096
  s_nop 0
  buffer_load_dwordx4 v2, s[52:55], s70 offen offset:1024 nt lds
  s_waitcnt vmcnt(7)
  s_add_u32 m0, s85, 4096
  s_nop 0
  buffer_load_dwordx4 v2, s[52:55], s70 offen offset:2048 nt lds
  s_waitcnt vmcnt(7)
  s_add_u32 m0, s85, 4096
  s_nop 0
  buffer_load_dwordx4 v2, s[52:55], s70 offen offset:3072 nt lds
  s_add_u32 s70, s70, 16384
  s_and_b32 s70, s70, 0x3ffff
  s_waitcnt vmcnt(7)
  s_add_u32 m0, s85, 8192
  s_nop 0
  buffer_load_dwordx4 v2, s[52:55], s70 offen offset:0 nt lds
  s_waitcnt vmcnt(7)
  s_add_u32 m0, s85, 8192
  s_nop 0
  buffer_load_dwordx4 v2, s[52:55], s70 offen offset:1024 nt lds
  s_waitcnt vmcnt(7)
  s_add_u32 m0, s85, 8192
  s_nop 0
  buffer_load_dwordx4 v2, s[52:55], s70 offen offset:2048 nt lds
  s_waitcnt vmcnt(7)
  s_add_u32 m0, s85, 8192
  s_nop 0
  buffer_load_dwordx4 v2, s[52:55], s70 offen offset:3072 nt lds
  s_waitcnt vmcnt(7)
  s_add_u32 m0, s85, 12288
  s_nop 0
  buffer_load_dwordx4 v3, s[56:59], s71 offen offset:0 nt lds
  s_waitcnt vmcnt(7)
  s_add_u32 m0, s85, 13056
  s_nop 0
  buffer_load_dwordx4 v3, s[56:59], s71 offen offset:256 nt lds
  s_waitcnt vmcnt(7)
  s_add_u32 m0, s85, 12288
  s_nop 0
  buffer_load_dwordx4 v3, s[56:59], s71 offen offset:2048 nt lds
  s_waitcnt vmcnt(7)
  s_add_u32 m0, s85, 13056
  s_nop 0
  buffer_load_dwordx4 v3, s[56:59], s71 offen offset:2304 nt lds
  s_add_u32 s71, s71, 16384
  s_and_b32 s71, s71, 0x3ffff
  s_waitcnt vmcnt(7)
  s_add_u32 m0, s85, 16384
  s_nop 0
  buffer_load_dwordx4 v3, s[56:59], s71 offen offset:0 nt lds
  s_waitcnt vmcnt(7)
  s_add_u32 m0, s85, 17152
  s_nop 0
  buffer_load_dwordx4 v3, s[56:59], s71 offen offset:256 nt lds
  s_waitcnt vmcnt(7)
  s_add_u32 m0, s85, 16384
  s_nop 0
  buffer_load_dwordx4 v3, s[56:59], s71 offen offset:2048 nt lds
  s_waitcnt vmcnt(7)
  s_add_u32 m0, s85, 17152
  s_nop 0
  buffer_load_dwordx4 v3, s[56:59], s71 offen offset:2304 nt lds
  s_add_u32 s71, s71, 16384
  s_and_b32 s71, s71, 0x3ffff
  s_waitcnt vmcnt(7)
  s_add_u32 m0, s85, 20480
  s_nop 0
  buffer_load_dwordx4 v3, s[56:59], s71 offen offset:0 nt lds
  s_waitcnt vmcnt(7)
  s_add_u32 m0, s85, 21248
  s_nop 0
  buffer_load_dwordx4 v3, s[56:59], s71 offen offset:256 nt lds
  s_waitcnt vmcnt(7)
  s_add_u32 m0, s85, 20480
  s_nop 0
  buffer_load_dwordx4 v3, s[56:59], s71 offen offset:2048 nt lds
  s_waitcnt vmcnt(7)
  s_add_u32 m0, s85, 21248
  s_nop 0
  buffer_load_dwordx4 v3, s[56:59], s71 offen offset:2304 nt lds
  s_add_u32 s71, s71, 16384
  s_and_b32 s71, s71, 0x3ffff
  s_waitcnt vmcnt(7)
  s_add_u32 m0, s85, 24576
  s_nop 0
  buffer_load_dwordx4 v3, s[56:59], s71 offen offset:0 nt lds
  s_waitcnt vmcnt(7)
  s_add_u32 m0, s85, 25344
  s_nop 0
  buffer_load_dwordx4 v3, s[56:59], s71 offen offset:256 nt lds
  s_waitcnt vmcnt(7)
  s_add_u32 m0, s85, 24576
  s_nop 0
  buffer_load_dwordx4 v3, s[56:59], s71 offen offset:2048 nt lds
  s_waitcnt vmcnt(7)
  s_add_u32 m0, s85, 25344
  s_nop 0
  buffer_load_dwordx4 v3, s[56:59], s71 offen offset:2304 nt lds
  s_add_u32 s71, s71, 16384
  s_and_b32 s71, s71, 0x3ffff
  s_waitcnt vmcnt(7)
  s_add_u32 m0, s85, 28672
  s_nop 0
  buffer_load_dwordx4 v3, s[56:59], s71 offen offset:0 nt lds
  s_waitcnt vmcnt(7)
  s_add_u32 m0, s85, 29440
  s_nop 0
  buffer_load_dwordx4 v3, s[56:59], s71 offen offset:256 nt lds
  s_waitcnt vmcnt(7)
  s_add_u32 m0, s85, 28672
  s_nop 0
  buffer_load_dwordx4 v3, s[56:59], s71 offen offset:2048 nt lds
  s_waitcnt vmcnt(7)
  s_add_u32 m0, s85, 29440
  s_nop 0
  buffer_load_dwordx4 v3, s[56:59], s71 offen offset:2304 nt lds
  s_add_u32 s71, s71, 16384
  s_and_b32 s71, s71, 0x3ffff
  s_waitcnt vmcnt(7)
  s_add_u32 m0, s85, 32768
  s_nop 0
  buffer_load_dwordx4 v3, s[56:59], s71 offen offset:0 nt lds
  s_waitcnt vmcnt(7)
  s_add_u32 m0, s85, 33536
  s_nop 0
  buffer_load_dwordx4 v3, s[56:59], s71 offen offset:256 nt lds
  s_waitcnt vmcnt(7)
  s_add_u32 m0, s85, 32768
  s_nop 0
  buffer_load_dwordx4 v3, s[56:59], s71 offen offset:2048 nt lds
  s_waitcnt vmcnt(7)
  s_add_u32 m0, s85, 33536
  s_nop 0
  buffer_load_dwordx4 v3, s[56:59], s71 offen offset:2304 nt lds
  s_add_u32 s71, s71, 16384
  s_and_b32 s71, s71, 0x3ffff
  v_mov_b32 v4, 0
L_spinQ:
  ds_read_b32 v5, v4 offset:8
  s_waitcnt lgkmcnt(0)
  v_readfirstlane_b32 s13, v5
  s_nop 0
  s_cmp_ge_u32 s13, 1
  s_cbranch_scc1 L_spunQ
  s_sub_u32 s84, s84, 1
  s_cbranch_scc1 L_fin
  s_branch L_spinQ
L_spunQ:
  ds_read_b32 v8, v4 offset:12
  ds_read_b128 v[4:7], v31 offset:256
  s_mov_b32 vcc_lo, 0xaaaaaaaa
  s_mov_b32 vcc_hi, 0xaaaaaaaa
  s_waitcnt lgkmcnt(0)
  v_readfirstlane_b32 s45, v8
  v_mfma_f32_16x16x32_bf16 v[20:23], v[32:35], v[4:7], 0
  v_mfma_f32_16x16x32_bf16 v[32:35], v[36:39], v[4:7], 0
  v_mfma_f32_16x16x32_bf16 v[36:39], v[40:43], v[4:7], 0
  v_mfma_f32_16x16x32_bf16 v[40:43], v[44:47], v[4:7], 0
  v_mfma_f32_16x16x32_bf16 v[44:47], v[48:51], v[4:7], 0
  v_mfma_f32_16x16x32_bf16 v[48:51], v[52:55], v[4:7], 0
  v_mfma_f32_16x16x32_bf16 v[52:55], v[56:59], v[4:7], 0
  v_mfma_f32_16x16x32_bf16 v[56:59], v[60:63], v[4:7], 0
  s_nop 0
  v_cndmask_b32 v20, v20, v21, vcc
  v_cndmask_b32 v22, v22, v23, vcc
  v_cndmask_b32 v32, v32, v33, vcc
  v_cndmask_b32 v34, v34, v35, vcc
  v_cndmask_b32 v36, v36, v37, vcc
  v_cndmask_b32 v38, v38, v39, vcc
  v_cndmask_b32 v40, v40, v41, vcc
  v_cndmask_b32 v42, v42, v43, vcc
  v_cndmask_b32 v44, v44, v45, vcc
  v_cndmask_b32 v46, v46, v47, vcc
  v_cndmask_b32 v48, v48, v49, vcc
  v_cndmask_b32 v50, v50, v51, vcc
  v_cndmask_b32 v52, v52, v53, vcc
  v_cndmask_b32 v54, v54, v55, vcc
  v_cndmask_b32 v56, v56, v57, vcc
  v_cndmask_b32 v58, v58, v59, vcc
  v_cndmask_b32 v20, v20, v22, s[80:81]
  v_cndmask_b32 v32, v32, v34, s[80:81]
  v_cndmask_b32 v36, v36, v38, s[80:81]
  v_cndmask_b32 v40, v40, v42, s[80:81]
  v_cndmask_b32 v44, v44, v46, s[80:81]
  v_cndmask_b32 v48, v48, v50, s[80:81]
  v_cndmask_b32 v52, v52, v54, s[80:81]
  v_cndmask_b32 v56, v56, v58, s[80:81]
  v_permlane16_swap_b32 v20, v32
  v_permlane16_swap_b32 v36, v40
  v_permlane16_swap_b32 v44, v48
  v_permlane16_swap_b32 v52, v56
  v_cndmask_b32 v20, v20, v32, s[82:83]
  v_cndmask_b32 v36, v36, v40, s[82:83]
  v_cndmask_b32 v44, v44, v48, s[82:83]
  v_cndmask_b32 v52, v52, v56, s[82:83]
  v_add_f32_dpp v21, v20, v20 row_shl:4 row_mask:0xf bank_mask:0x5
  v_add_f32_dpp v37, v36, v36 row_shl:4 row_mask:0xf bank_mask:0x5
  s_nop 0
  v_add_f32_dpp v21, v44, v44 row_shr:4 row_mask:0xf bank_mask:0xa
  v_add_f32_dpp v37, v52, v52 row_shr:4 row_mask:0xf bank_mask:0xa
  v_cndmask_b32 v38, v37, v21, s[80:81]
  v_cndmask_b32 v22, v21, v37, s[80:81]
  s_nop 1
  v_add_f32_dpp v22, v38, v22 quad_perm:[2,3,0,1] row_mask:0xf bank_mask:0xf
  s_nop 1
  v_add_f32_dpp v8, v22, v22 quad_perm:[1,0,3,2] row_mask:0xf bank_mask:0xf
  v_cvt_pk_bf16_f32 v8, v8, v8
  v_and_b32 v8, s46, v8
  v_mfma_f32_16x16x32_bf16 v[60:63], v[64:67], v[4:7], 0
  v_mfma_f32_16x16x32_bf16 v[64:67], v[68:71], v[4:7], 0
  v_mfma_f32_16x16x32_bf16 v[68:71], v[72:75], v[4:7], 0
  v_mfma_f32_16x16x32_bf16 v[72:75], v[76:79], v[4:7], 0
  v_mfma_f32_16x16x32_bf16 v[76:79], v[80:83], v[4:7], 0
  v_mfma_f32_16x16x32_bf16 v[80:83], v[84:87], v[4:7], 0
  v_mfma_f32_16x16x32_bf16 v[84:87], v[88:91], v[4:7], 0
  v_mfma_f32_16x16x32_bf16 v[88:91], v[92:95], v[4:7], 0
  s_nop 0
  v_cndmask_b32 v60, v60, v61, vcc
  v_cndmask_b32 v62, v62, v63, vcc
  v_cndmask_b32 v64, v64, v65, vcc
  v_cndmask_b32 v66, v66, v67, vcc
  v_cndmask_b32 v68, v68, v69, vcc
  v_cndmask_b32 v70, v70, v71, vcc
  v_cndmask_b32 v72, v72, v73, vcc
  v_cndmask_b32 v74, v74, v75, vcc
  v_cndmask_b32 v76, v76, v77, vcc
  v_cndmask_b32 v78, v78, v79, vcc
  v_cndmask_b32 v80, v80, v81, vcc
  v_cndmask_b32 v82, v82, v83, vcc
  v_cndmask_b32 v84, v84, v85, vcc
  v_cndmask_b32 v86, v86, v87, vcc
  v_cndmask_b32 v88, v88, v89, vcc
  v_cndmask_b32 v90, v90, v91, vcc
  v_cndmask_b32 v60, v60, v62, s[80:81]
  v_cndmask_b32 v64, v64, v66, s[80:81]
  v_cndmask_b32 v68, v68, v70, s[80:81]
  v_cndmask_b32 v72, v72, v74, s[80:81]
  v_cndmask_b32 v76, v76, v78, s[80:81]
  v_cndmask_b32 v80, v80, v82, s[80:81]
  v_cndmask_b32 v84, v84, v86, s[80:81]
  v_cndmask_b32 v88, v88, v90, s[80:81]
  v_permlane16_swap_b32 v60, v64
  v_permlane16_swap_b32 v68, v72
  v_permlane16_swap_b32 v76, v80
  v_permlane16_swap_b32 v84, v88
  v_cndmask_b32 v60, v60, v64, s[82:83]
  v_cndmask_b32 v68, v68, v72, s[82:83]
  v_cndmask_b32 v76, v76, v80, s[82:83]
  v_cndmask_b32 v84, v84, v88, s[82:83]
  v_add_f32_dpp v61, v60, v60 row_shl:4 row_mask:0xf bank_mask:0x5
  v_add_f32_dpp v69, v68, v68 row_shl:4 row_mask:0xf bank_mask:0x5
  s_nop 0
  v_add_f32_dpp v61, v76, v76 row_shr:4 row_mask:0xf bank_mask:0xa
  v_add_f32_dpp v69, v84, v84 row_shr:4 row_mask:0xf bank_mask:0xa
  v_cndmask_b32 v70, v69, v61, s[80:81]
  v_cndmask_b32 v62, v61, v69, s[80:81]
  s_nop 1
  v_add_f32_dpp v62, v70, v62 quad_perm:[2,3,0,1] row_mask:0xf bank_mask:0xf
  s_nop 1
  v_add_f32_dpp v9, v62, v62 quad_perm:[1,0,3,2] row_mask:0xf bank_mask:0xf
  v_cvt_pk_bf16_f32 v9, v9, v9
  v_and_b32 v9, s46, v9
  s_waitcnt vmcnt(9)
  buffer_load_dwordx4 v[64:67], v3, s[56:59], s71 offen offset:0 nt
  s_waitcnt vmcnt(9)
  buffer_load_dwordx4 v[68:71], v3, s[56:59], s71 offen offset:256 nt
  s_waitcnt vmcnt(9)
  buffer_load_dwordx4 v[72:75], v3, s[56:59], s71 offen offset:2048 nt
  s_waitcnt vmcnt(9)
  buffer_load_dwordx4 v[76:79], v3, s[56:59], s71 offen offset:2304 nt
  s_add_u32 s71, s71, 16384
  s_and_b32 s71, s71, 0x3ffff
  s_waitcnt vmcnt(9)
  buffer_load_dwordx4 v[80:83], v3, s[56:59], s71 offen offset:0 nt
  v_mfma_f32_16x16x32_bf16 v[92:95], v[96:99], v[4:7], 0
  v_mfma_f32_16x16x32_bf16 v[96:99], v[100:103], v[4:7], 0
  v_mfma_f32_16x16x32_bf16 v[100:103], v[104:107], v[4:7], 0
  v_mfma_f32_16x16x32_bf16 v[104:107], v[108:111], v[4:7], 0
  v_mfma_f32_16x16x32_bf16 v[108:111], v[112:115], v[4:7], 0
  v_mfma_f32_16x16x32_bf16 v[112:115], v[116:119], v[4:7], 0
  v_mfma_f32_16x16x32_bf16 v[116:119], v[120:123], v[4:7], 0
  v_mfma_f32_16x16x32_bf16 v[120:123], v[124:127], v[4:7], 0
  s_nop 0
  v_cndmask_b32 v92, v92, v93, vcc
  v_cndmask_b32 v94, v94, v95, vcc
  v_cndmask_b32 v96, v96, v97, vcc
  v_cndmask_b32 v98, v98, v99, vcc
  v_cndmask_b32 v100, v100, v101, vcc
  v_cndmask_b32 v102, v102, v103, vcc
  v_cndmask_b32 v104, v104, v105, vcc
  v_cndmask_b32 v106, v106, v107, vcc
  v_cndmask_b32 v108, v108, v109, vcc
  v_cndmask_b32 v110, v110, v111, vcc
  v_cndmask_b32 v112, v112, v113, vcc
  v_cndmask_b32 v114, v114, v115, vcc
  v_cndmask_b32 v116, v116, v117, vcc
  v_cndmask_b32 v118, v118, v119, vcc
  v_cndmask_b32 v120, v120, v121, vcc
  v_cndmask_b32 v122, v122, v123, vcc
  v_cndmask_b32 v92, v92, v94, s[80:81]
  v_cndmask_b32 v96, v96, v98, s[80:81]
  v_cndmask_b32 v100, v100, v102, s[80:81]
  v_cndmask_b32 v104, v104, v106, s[80:81]
  v_cndmask_b32 v108, v108, v110, s[80:81]
  v_cndmask_b32 v112, v112, v114, s[80:81]
  v_cndmask_b32 v116, v116, v118, s[80:81]
  v_cndmask_b32 v120, v120, v122, s[80:81]
  v_permlane16_swap_b32 v92, v96
  v_permlane16_swap_b32 v100, v104
  v_permlane16_swap_b32 v108, v112
  v_permlane16_swap_b32 v116, v120
  v_cndmask_b32 v92, v92, v96, s[82:83]
  v_cndmask_b32 v100, v100, v104, s[82:83]
  v_cndmask_b32 v108, v108, v112, s[82:83]
  v_cndmask_b32 v116, v116, v120, s[82:83]
  v_add_f32_dpp v93, v92, v92 row_shl:4 row_mask:0xf bank_mask:0x5
  v_add_f32_dpp v101, v100, v100 row_shl:4 row_mask:0xf bank_mask:0x5
  s_nop 0
  v_add_f32_dpp v93, v108, v108 row_shr:4 row_mask:0xf bank_mask:0xa
  v_add_f32_dpp v101, v116, v116 row_shr:4 row_mask:0xf bank_mask:0xa
  v_cndmask_b32 v102, v101, v93, s[80:81]
  v_cndmask_b32 v94, v93, v101, s[80:81]
  s_nop 1
  v_add_f32_dpp v94, v102, v94 quad_perm:[2,3,0,1] row_mask:0xf bank_mask:0xf
  s_nop 1
  v_add_f32_dpp v10, v94, v94 quad_perm:[1,0,3,2] row_mask:0xf bank_mask:0xf
  v_cvt_pk_bf16_f32 v10, v10, v10
  v_and_b32 v10, s46, v10
  s_waitcnt vmcnt(9)
  buffer_load_dwordx4 v[84:87], v3, s[56:59], s71 offen offset:256 nt
  s_waitcnt vmcnt(9)
  buffer_load_dwordx4 v[88:91], v3, s[56:59], s71 offen offset:2048 nt
  s_waitcnt vmcnt(9)
  buffer_load_dwordx4 v[92:95], v3, s[56:59], s71 offen offset:2304 nt
  s_add_u32 s71, s71, 16384
  s_and_b32 s71, s71, 0x3ffff
  s_waitcnt vmcnt(9)
  buffer_load_dwordx4 v[96:99], v3, s[56:59], s71 offen offset:0 nt
  v_mfma_f32_16x16x32_bf16 v[124:127], v[128:131], v[4:7], 0
  v_mfma_f32_16x16x32_bf16 v[128:131], v[132:135], v[4:7], 0
  v_mfma_f32_16x16x32_bf16 v[132:135], v[136:139], v[4:7], 0
  v_mfma_f32_16x16x32_bf16 v[136:139], v[140:143], v[4:7], 0
  v_mfma_f32_16x16x32_bf16 v[140:143], v[144:147], v[4:7], 0
  v_mfma_f32_16x16x32_bf16 v[144:147], v[148:151], v[4:7], 0
  v_mfma_f32_16x16x32_bf16 v[148:151], v[152:155], v[4:7], 0
  v_mfma_f32_16x16x32_bf16 v[152:155], v[156:159], v[4:7], 0
  s_nop 0
  v_cndmask_b32 v124, v124, v125, vcc
  v_cndmask_b32 v126, v126, v127, vcc
  v_cndmask_b32 v128, v128, v129, vcc
  v_cndmask_b32 v130, v130, v131, vcc
  v_cndmask_b32 v132, v132, v133, vcc
  v_cndmask_b32 v134, v134, v135, vcc
  v_cndmask_b32 v136, v136, v137, vcc
  v_cndmask_b32 v138, v138, v139, vcc
  v_cndmask_b32 v140, v140, v141, vcc
  v_cndmask_b32 v142, v142, v143, vcc
  v_cndmask_b32 v144, v144, v145, vcc
  v_cndmask_b32 v146, v146, v147, vcc
  v_cndmask_b32 v148, v148, v149, vcc
  v_cndmask_b32 v150, v150, v151, vcc
  v_cndmask_b32 v152, v152, v153, vcc
  v_cndmask_b32 v154, v154, v155, vcc
  v_cndmask_b32 v124, v124, v126, s[80:81]
  v_cndmask_b32 v128, v128, v130, s[80:81]
  v_cndmask_b32 v132, v132, v134, s[80:81]
  v_cndmask_b32 v136, v136, v138, s[80:81]
  v_cndmask_b32 v140, v140, v142, s[80:81]
  v_cndmask_b32 v144, v144, v146, s[80:81]
  v_cndmask_b32 v148, v148, v150, s[80:81]
  v_cndmask_b32 v152, v152, v154, s[80:81]
  v_permlane16_swap_b32 v124, v128
  v_permlane16_swap_b32 v132, v136
  v_permlane16_swap_b32 v140, v144
  v_permlane16_swap_b32 v148, v152
  v_cndmask_b32 v124, v124, v128, s[82:83]
  v_cndmask_b32 v132, v132, v136, s[82:83]
  v_cndmask_b32 v140, v140, v144, s[82:83]
  v_cndmask_b32 v148, v148, v152, s[82:83]
  v_add_f32_dpp v125, v124, v124 row_shl:4 row_mask:0xf bank_mask:0x5
  v_add_f32_dpp v133, v132, v132 row_shl:4 row_mask:0xf bank_mask:0x5
  s_nop 0
  v_add_f32_dpp v125, v140, v140 row_shr:4 row_mask:0xf bank_mask:0xa
  v_add_f32_dpp v133, v148, v148 row_shr:4 row_mask:0xf bank_mask:0xa
  v_cndmask_b32 v134, v133, v125, s[80:81]
  v_cndmask_b32 v126, v125, v133, s[80:81]
  s_nop 1
  v_add_f32_dpp v126, v134, v126 quad_perm:[2,3,0,1] row_mask:0xf bank_mask:0xf
  s_nop 1
  v_add_f32_dpp v11, v126, v126 quad_perm:[1,0,3,2] row_mask:0xf bank_mask:0xf
  v_cvt_pk_bf16_f32 v11, v11, v11
  v_and_b32 v11, s46, v11
  s_waitcnt vmcnt(9)
  buffer_load_dwordx4 v[100:103], v3, s[56:59], s71 offen offset:256 nt
  s_waitcnt vmcnt(9)
  buffer_load_dwordx4 v[104:107], v3, s[56:59], s71 offen offset:2048 nt
  s_waitcnt vmcnt(9)
  buffer_load_dwordx4 v[108:111], v3, s[56:59], s71 offen offset:2304 nt
  s_add_u32 s71, s71, 16384
  s_and_b32 s71, s71, 0x3ffff
  s_waitcnt vmcnt(9)
  buffer_load_dwordx4 v[112:115], v3, s[56:59], s71 offen offset:0 nt
  v_mfma_f32_16x16x32_bf16 v[156:159], v[160:163], v[4:7], 0
  v_mfma_f32_16x16x32_bf16 v[160:163], v[164:167], v[4:7], 0
  v_mfma_f32_16x16x32_bf16 v[164:167], v[168:171], v[4:7], 0
  v_mfma_f32_16x16x32_bf16 v[168:171], v[172:175], v[4:7], 0
  v_mfma_f32_16x16x32_bf16 v[172:175], v[176:179], v[4:7], 0
  v_mfma_f32_16x16x32_bf16 v[176:179], v[180:183], v[4:7], 0
  v_mfma_f32_16x16x32_bf16 v[180:183], v[184:187], v[4:7], 0
  v_mfma_f32_16x16x32_bf16 v[184:187], v[188:191], v[4:7], 0
  s_nop 0
  v_cndmask_b32 v156, v156, v157, vcc
  v_cndmask_b32 v158, v158, v159, vcc
  v_cndmask_b32 v160, v160, v161, vcc
  v_cndmask_b32 v162, v162, v163, vcc
  v_cndmask_b32 v164, v164, v165, vcc
  v_cndmask_b32 v166, v166, v167, vcc
  v_cndmask_b32 v168, v168, v169, vcc
  v_cndmask_b32 v170, v170, v171, vcc
  v_cndmask_b32 v172, v172, v173, vcc
  v_cndmask_b32 v174, v174, v175, vcc
  v_cndmask_b32 v176, v176, v177, vcc
  v_cndmask_b32 v178, v178, v179, vcc
  v_cndmask_b32 v180, v180, v181, vcc
  v_cndmask_b32 v182, v182, v183, vcc
  v_cndmask_b32 v184, v184, v185, vcc
  v_cndmask_b32 v186, v186, v187, vcc
  v_cndmask_b32 v156, v156, v158, s[80:81]
  v_cndmask_b32 v160, v160, v162, s[80:81]
  v_cndmask_b32 v164, v164, v166, s[80:81]
  v_cndmask_b32 v168, v168, v170, s[80:81]
  v_cndmask_b32 v172, v172, v174, s[80:81]
  v_cndmask_b32 v176, v176, v178, s[80:81]
  v_cndmask_b32 v180, v180, v182, s[80:81]
  v_cndmask_b32 v184, v184, v186, s[80:81]
  v_permlane16_swap_b32 v156, v160
  v_permlane16_swap_b32 v164, v168
  v_permlane16_swap_b32 v172, v176
  v_permlane16_swap_b32 v180, v184
  v_cndmask_b32 v156, v156, v160, s[82:83]
  v_cndmask_b32 v164, v164, v168, s[82:83]
  v_cndmask_b32 v172, v172, v176, s[82:83]
  v_cndmask_b32 v180, v180, v184, s[82:83]
  v_add_f32_dpp v157, v156, v156 row_shl:4 row_mask:0xf bank_mask:0x5
  v_add_f32_dpp v165, v164, v164 row_shl:4 row_mask:0xf bank_mask:0x5
  s_nop 0
  v_add_f32_dpp v157, v172, v172 row_shr:4 row_mask:0xf bank_mask:0xa
  v_add_f32_dpp v165, v180, v180 row_shr:4 row_mask:0xf bank_mask:0xa
  v_cndmask_b32 v166, v165, v157, s[80:81]
  v_cndmask_b32 v158, v157, v165, s[80:81]
  s_nop 1
  v_add_f32_dpp v158, v166, v158 quad_perm:[2,3,0,1] row_mask:0xf bank_mask:0xf
  s_nop 1
  v_add_f32_dpp v12, v158, v158 quad_perm:[1,0,3,2] row_mask:0xf bank_mask:0xf
  v_cvt_pk_bf16_f32 v12, v12, v12
  v_and_b32 v12, s46, v12
  s_waitcnt vmcnt(9)
  buffer_load_dwordx4 v[116:119], v3, s[56:59], s71 offen offset:256 nt
  s_waitcnt vmcnt(9)
  buffer_load_dwordx4 v[120:123], v3, s[56:59], s71 offen offset:2048 nt
  s_waitcnt vmcnt(9)
  buffer_load_dwordx4 v[124:127], v3, s[56:59], s71 offen offset:2304 nt
  s_add_u32 s71, s71, 16384
  s_and_b32 s71, s71, 0x3ffff
  v_mfma_f32_16x16x32_bf16 v[188:191], v[192:195], v[4:7], 0
  v_mfma_f32_16x16x32_bf16 v[192:195], v[196:199], v[4:7], 0
  v_mfma_f32_16x16x32_bf16 v[196:199], v[200:203], v[4:7], 0
  v_mfma_f32_16x16x32_bf16 v[200:203], v[204:207], v[4:7], 0
  v_mfma_f32_16x16x32_bf16 v[204:207], v[208:211], v[4:7], 0
  v_mfma_f32_16x16x32_bf16 v[208:211], v[212:215], v[4:7], 0
  v_mfma_f32_16x16x32_bf16 v[212:215], v[216:219], v[4:7], 0
  v_mfma_f32_16x16x32_bf16 v[216:219], v[220:223], v[4:7], 0
  s_nop 0
  v_cndmask_b32 v188, v188, v189, vcc
  v_cndmask_b32 v190, v190, v191, vcc
  v_cndmask_b32 v192, v192, v193, vcc
  v_cndmask_b32 v194, v194, v195, vcc
  v_cndmask_b32 v196, v196, v197, vcc
  v_cndmask_b32 v198, v198, v199, vcc
  v_cndmask_b32 v200, v200, v201, vcc
  v_cndmask_b32 v202, v202, v203, vcc
  v_cndmask_b32 v204, v204, v205, vcc
  v_cndmask_b32 v206, v206, v207, vcc
  v_cndmask_b32 v208, v208, v209, vcc
  v_cndmask_b32 v210, v210, v211, vcc
  v_cndmask_b32 v212, v212, v213, vcc
  v_cndmask_b32 v214, v214, v215, vcc
  v_cndmask_b32 v216, v216, v217, vcc
  v_cndmask_b32 v218, v218, v219, vcc
  v_cndmask_b32 v188, v188, v190, s[80:81]
  v_cndmask_b32 v192, v192, v194, s[80:81]
  v_cndmask_b32 v196, v196, v198, s[80:81]
  v_cndmask_b32 v200, v200, v202, s[80:81]
  v_cndmask_b32 v204, v204, v206, s[80:81]
  v_cndmask_b32 v208, v208, v210, s[80:81]
  v_cndmask_b32 v212, v212, v214, s[80:81]
  v_cndmask_b32 v216, v216, v218, s[80:81]
  v_permlane16_swap_b32 v188, v192
  v_permlane16_swap_b32 v196, v200
  v_permlane16_swap_b32 v204, v208
  v_permlane16_swap_b32 v212, v216
  v_cndmask_b32 v188, v188, v192, s[82:83]
  v_cndmask_b32 v196, v196, v200, s[82:83]
  v_cndmask_b32 v204, v204, v208, s[82:83]
  v_cndmask_b32 v212, v212, v216, s[82:83]
  v_add_f32_dpp v189, v188, v188 row_shl:4 row_mask:0xf bank_mask:0x5
  v_add_f32_dpp v197, v196, v196 row_shl:4 row_mask:0xf bank_mask:0x5
  s_nop 0
  v_add_f32_dpp v189, v204, v204 row_shr:4 row_mask:0xf bank_mask:0xa
  v_add_f32_dpp v197, v212, v212 row_shr:4 row_mask:0xf bank_mask:0xa
  v_cndmask_b32 v198, v197, v189, s[80:81]
  v_cndmask_b32 v190, v189, v197, s[80:81]
  s_nop 1
  v_add_f32_dpp v190, v198, v190 quad_perm:[2,3,0,1] row_mask:0xf bank_mask:0xf
  s_nop 1
  v_add_f32_dpp v13, v190, v190 quad_perm:[1,0,3,2] row_mask:0xf bank_mask:0xf
  v_cvt_pk_bf16_f32 v13, v13, v13
  v_and_b32 v13, s46, v13
  s_waitcnt vmcnt(40)
  ds_read_b128 v[32:35], v30 offset:0
  ds_read_b128 v[36:39], v30 offset:1024
  ds_read_b128 v[40:43], v30 offset:2048
  ds_read_b128 v[44:47], v30 offset:3072
  ds_read_b128 v[48:51], v30 offset:4096
  ds_read_b128 v[52:55], v30 offset:5120
  ds_read_b128 v[56:59], v30 offset:6144
  ds_read_b128 v[60:63], v30 offset:7168
  s_waitcnt vmcnt(9)
  global_load_dwordx4 v[128:131], v[28:29], off
  v_add_co_u32 v28, s[14:15], s72, v28
  s_nop 1
  v_addc_co_u32 v29, s[14:15], 0, v29, s[14:15]
  s_waitcnt vmcnt(9)
  global_load_dwordx4 v[132:135], v[28:29], off
  v_add_co_u32 v28, s[14:15], s72, v28
  s_nop 1
  v_addc_co_u32 v29, s[14:15], 0, v29, s[14:15]
  v_mfma_f32_16x16x32_bf16 v[220:223], v[224:227], v[4:7], 0
  v_mfma_f32_16x16x32_bf16 v[224:227], v[228:231], v[4:7], 0
  v_mfma_f32_16x16x32_bf16 v[228:231], v[232:235], v[4:7], 0
  v_mfma_f32_16x16x32_bf16 v[232:235], v[236:239], v[4:7], 0
  v_mfma_f32_16x16x32_bf16 v[236:239], v[240:243], v[4:7], 0
  v_mfma_f32_16x16x32_bf16 v[240:243], v[244:247], v[4:7], 0
  v_mfma_f32_16x16x32_bf16 v[244:247], v[248:251], v[4:7], 0
  v_mfma_f32_16x16x32_bf16 v[248:251], v[252:255], v[4:7], 0
  s_nop 0
  v_cndmask_b32 v220, v220, v221, vcc
  v_cndmask_b32 v222, v222, v223, vcc
  v_cndmask_b32 v224, v224, v225, vcc
  v_cndmask_b32 v226, v226, v227, vcc
  v_cndmask_b32 v228, v228, v229, vcc
  v_cndmask_b32 v230, v230, v231, vcc
  v_cndmask_b32 v232, v232, v233, vcc
  v_cndmask_b32 v234, v234, v235, vcc
  v_cndmask_b32 v236, v236, v237, vcc
  v_cndmask_b32 v238, v238, v239, vcc
  v_cndmask_b32 v240, v240, v241, vcc
  v_cndmask_b32 v242, v242, v243, vcc
  v_cndmask_b32 v244, v244, v245, vcc
  v_cndmask_b32 v246, v246, v247, vcc
  v_cndmask_b32 v248, v248, v249, vcc
  v_cndmask_b32 v250, v250, v251, vcc
  v_cndmask_b32 v220, v220, v222, s[80:81]
  v_cndmask_b32 v224, v224, v226, s[80:81]
  v_cndmask_b32 v228, v228, v230, s[80:81]
  v_cndmask_b32 v232, v232, v234, s[80:81]
  v_cndmask_b32 v236, v236, v238, s[80:81]
  v_cndmask_b32 v240, v240, v242, s[80:81]
  v_cndmask_b32 v244, v244, v246, s[80:81]
  v_cndmask_b32 v248, v248, v250, s[80:81]
  v_permlane16_swap_b32 v220, v224
  v_permlane16_swap_b32 v228, v232
  v_permlane16_swap_b32 v236, v240
  v_permlane16_swap_b32 v244, v248
  v_cndmask_b32 v220, v220, v224, s[82:83]
  v_cndmask_b32 v228, v228, v232, s[82:83]
  v_cndmask_b32 v236, v236, v240, s[82:83]
  v_cndmask_b32 v244, v244, v248, s[82:83]
  v_add_f32_dpp v221, v220, v220 row_shl:4 row_mask:0xf bank_mask:0x5
  v_add_f32_dpp v229, v228, v228 row_shl:4 row_mask:0xf bank_mask:0x5
  s_nop 0
  v_add_f32_dpp v221, v236, v236 row_shr:4 row_mask:0xf bank_mask:0xa
  v_add_f32_dpp v229, v244, v244 row_shr:4 row_mask:0xf bank_mask:0xa
  v_cndmask_b32 v230, v229, v221, s[80:81]
  v_cndmask_b32 v222, v221, v229, s[80:81]
  s_nop 1
  v_add_f32_dpp v222, v230, v222 quad_perm:[2,3,0,1] row_mask:0xf bank_mask:0xf
  s_nop 1
  v_add_f32_dpp v14, v222, v222 quad_perm:[1,0,3,2] row_mask:0xf bank_mask:0xf
  v_cvt_pk_bf16_f32 v14, v14, v14
  v_and_b32 v14, s46, v14
  s_waitcnt vmcnt(9)
  global_load_dwordx4 v[136:139], v[28:29], off
  v_add_co_u32 v28, s[14:15], s72, v28
  s_nop 1
  v_addc_co_u32 v29, s[14:15], 0, v29, s[14:15]
  s_waitcnt vmcnt(9)
  global_load_dwordx4 v[140:143], v[28:29], off
  v_add_co_u32 v28, s[14:15], s72, v28
  s_nop 1
  v_addc_co_u32 v29, s[14:15], 0, v29, s[14:15]
  s_waitcnt lgkmcnt(0)
  v_mfma_f32_16x16x32_bf16 v[252:255], v[32:35], v[4:7], 0
  v_mfma_f32_16x16x32_bf16 v[32:35], v[36:39], v[4:7], 0
  v_mfma_f32_16x16x32_bf16 v[36:39], v[40:43], v[4:7], 0
  v_mfma_f32_16x16x32_bf16 v[40:43], v[44:47], v[4:7], 0
  v_mfma_f32_16x16x32_bf16 v[44:47], v[48:51], v[4:7], 0
  v_mfma_f32_16x16x32_bf16 v[48:51], v[52:55], v[4:7], 0
  v_mfma_f32_16x16x32_bf16 v[52:55], v[56:59], v[4:7], 0
  v_mfma_f32_16x16x32_bf16 v[56:59], v[60:63], v[4:7], 0
  s_nop 0
  v_cndmask_b32 v252, v252, v253, vcc
  v_cndmask_b32 v254, v254, v255, vcc
  v_cndmask_b32 v32, v32, v33, vcc
  v_cndmask_b32 v34, v34, v35, vcc
  v_cndmask_b32 v36, v36, v37, vcc
  v_cndmask_b32 v38, v38, v39, vcc
  v_cndmask_b32 v40, v40, v41, vcc
  v_cndmask_b32 v42, v42, v43, vcc
  v_cndmask_b32 v44, v44, v45, vcc
  v_cndmask_b32 v46, v46, v47, vcc
  v_cndmask_b32 v48, v48, v49, vcc
  v_cndmask_b32 v50, v50, v51, vcc
  v_cndmask_b32 v52, v52, v53, vcc
  v_cndmask_b32 v54, v54, v55, vcc
  v_cndmask_b32 v56, v56, v57, vcc
  v_cndmask_b32 v58, v58, v59, vcc
  v_cndmask_b32 v252, v252, v254, s[80:81]
  v_cndmask_b32 v32, v32, v34, s[80:81]
  v_cndmask_b32 v36, v36, v38, s[80:81]
  v_cndmask_b32 v40, v40, v42, s[80:81]
  v_cndmask_b32 v44, v44, v46, s[80:81]
  v_cndmask_b32 v48, v48, v50, s[80:81]
  v_cndmask_b32 v52, v52, v54, s[80:81]
  v_cndmask_b32 v56, v56, v58, s[80:81]
  v_permlane16_swap_b32 v252, v32
  v_permlane16_swap_b32 v36, v40
  v_permlane16_swap_b32 v44, v48
  v_permlane16_swap_b32 v52, v56
  v_cndmask_b32 v252, v252, v32, s[82:83]
  v_cndmask_b32 v36, v36, v40, s[82:83]
  v_cndmask_b32 v44, v44, v48, s[82:83]
  v_cndmask_b32 v52, v52, v56, s[82:83]
  v_add_f32_dpp v253, v252, v252 row_shl:4 row_mask:0xf bank_mask:0x5
  v_add_f32_dpp v37, v36, v36 row_shl:4 row_mask:0xf bank_mask:0x5
  s_nop 0
  v_add_f32_dpp v253, v44, v44 row_shr:4 row_mask:0xf bank_mask:0xa
  v_add_f32_dpp v37, v52, v52 row_shr:4 row_mask:0xf bank_mask:0xa
  v_cndmask_b32 v38, v37, v253, s[80:81]
  v_cndmask_b32 v254, v253, v37, s[80:81]
  s_nop 1
  v_add_f32_dpp v254, v38, v254 quad_perm:[2,3,0,1] row_mask:0xf bank_mask:0xf
  s_nop 1
  v_add_f32_dpp v15, v254, v254 quad_perm:[1,0,3,2] row_mask:0xf bank_mask:0xf
  v_cvt_pk_bf16_f32 v15, v15, v15
  v_and_b32 v15, s46, v15
  s_waitcnt vmcnt(9)
  global_load_dwordx4 v[144:147], v[28:29], off
  v_add_co_u32 v28, s[14:15], s72, v28
  s_nop 1
  v_addc_co_u32 v29, s[14:15], 0, v29, s[14:15]
  s_waitcnt vmcnt(9)
  global_load_dwordx4 v[148:151], v[28:29], off
  v_add_co_u32 v28, s[14:15], s72, v28
  s_nop 1
  v_addc_co_u32 v29, s[14:15], 0, v29, s[14:15]
  s_waitcnt vmcnt(22)
  ds_read_b128 v[32:35], v30 offset:8192
  ds_read_b128 v[36:39], v30 offset:9216
  ds_read_b128 v[40:43], v30 offset:10240
  ds_read_b128 v[44:47], v30 offset:11264
  v_max3_f32 v20, v8, v9, v10
  v_max3_f32 v21, v11, v12, v13
  v_max3_f32 v20, v20, v14, v15
  v_max_f32 v20, v20, v21
  s_nop 1
  v_max_f32_dpp v20, v20, v20 quad_perm:[2,3,0,1] row_mask:0xf bank_mask:0xf
  s_nop 1
  v_max_f32_dpp v20, v20, v20 row_half_mirror row_mask:0xf bank_mask:0xf
  v_mov_b32 v21, v20
  s_nop 1
  v_permlane16_swap_b32 v20, v21
  v_max_f32 v20, v20, v21
  v_mov_b32 v21, v20
  s_nop 1
  v_permlane32_swap_b32 v20, v21
  v_max_f32 v20, v20, v21
  s_mov_b32 s69, 0x3db8aa3b
  v_mul_f32 v22, s69, v20
  v_fma_f32 v8, v8, s69, -v22
  v_fma_f32 v9, v9, s69, -v22
  v_fma_f32 v10, v10, s69, -v22
  v_fma_f32 v11, v11, s69, -v22
  v_fma_f32 v12, v12, s69, -v22
  v_fma_f32 v13, v13, s69, -v22
  v_fma_f32 v14, v14, s69, -v22
  v_fma_f32 v15, v15, s69, -v22
  v_exp_f32 v8, v8
  v_exp_f32 v9, v9
  v_exp_f32 v10, v10
  v_exp_f32 v11, v11
  v_exp_f32 v12, v12
  v_exp_f32 v13, v13
  v_exp_f32 v14, v14
  v_exp_f32 v15, v15
  v_add_f32 v21, v8, v9
  v_add_f32 v22, v10, v11
  v_add_f32 v23, v12, v13
  v_add_f32 v24, v14, v15
  v_add_f32 v21, v21, v22
  v_add_f32 v23, v23, v24
  v_add_f32 v21, v21, v23
  v_cvt_pk_bf16_f32 v8, v8, v8
  v_cvt_pk_bf16_f32 v9, v9, v9
  v_cvt_pk_bf16_f32 v10, v10, v10
  v_cvt_pk_bf16_f32 v11, v11, v11
  v_cvt_pk_bf16_f32 v12, v12, v12
  v_cvt_pk_bf16_f32 v13, v13, v13
  v_cvt_pk_bf16_f32 v14, v14, v14
  v_cvt_pk_bf16_f32 v15, v15, v15
  v_add_f32_dpp v21, v21, v21 quad_perm:[2,3,0,1] row_mask:0xf bank_mask:0xf
  s_nop 1
  v_add_f32_dpp v21, v21, v21 row_half_mirror row_mask:0xf bank_mask:0xf
  v_mov_b32 v22, v21
  s_nop 1
  v_permlane16_swap_b32 v21, v22
  v_add_f32 v21, v21, v22
  v_mov_b32 v22, v21
  s_nop 1
  v_permlane32_swap_b32 v21, v22
  v_add_f32 v21, v21, v22
  s_lshl_b32 s69, s3, 4
  v_add_u32 v22, s69, v1
  v_mov_b32 v23, 0
  v_mov_b32 v24, 1
  s_mov_b64 exec, 0x101
  ds_write_b64 v22, v[20:21] offset:128
  s_mov_b64 exec, 1
  ds_add_u32 v23, v24 offset:4
  s_mov_b64 exec, -1
  s_mov_b32 s13, 0
  s_or_b32 s13, s13, s12
  s_or_b32 s13, s13, s9
  s_and_b32 s14, s47, 3
  s_cmp_eq_u32 s14, 3
  s_cselect_b32 s14, 1, 0
  s_or_b32 s13, s13, s14
  s_mov_b32 vcc_lo, s13
  s_mov_b32 vcc_hi, 0
  v_and_b32 v224, v8, v16
  v_and_b32_dpp v225, v8, v17 row_shr:2 row_mask:0xf bank_mask:0xf bound_ctrl:0
  v_and_b32_dpp v226, v8, v18 row_shr:4 row_mask:0xf bank_mask:0xf bound_ctrl:0
  v_and_b32_dpp v227, v8, v19 row_shr:6 row_mask:0xf bank_mask:0xf bound_ctrl:0
  v_and_b32_dpp v228, v8, v16 row_shl:2 row_mask:0xf bank_mask:0xf bound_ctrl:0
  v_and_b32 v229, v8, v17
  v_and_b32_dpp v230, v8, v18 row_shr:2 row_mask:0xf bank_mask:0xf bound_ctrl:0
  v_and_b32_dpp v231, v8, v19 row_shr:4 row_mask:0xf bank_mask:0xf bound_ctrl:0
  ds_read_b128 v[48:51], v30 offset:12288
  ds_read_b128 v[52:55], v30 offset:13312
  s_waitcnt lgkmcnt(4)
  v_mfma_f32_16x16x32_bf16 v[20:23], v[224:227], v[32:35], 0
  v_mfma_f32_16x16x32_bf16 v[24:27], v[224:227], v[36:39], 0
  s_waitcnt vmcnt(9)
  global_load_dwordx4 v[152:155], v[28:29], off
  v_add_co_u32 v28, s[14:15], s72, v28
  s_nop 1
  v_addc_co_u32 v29, s[14:15], 0, v29, s[14:15]
  v_and_b32_dpp v224, v8, v16 row_shl:4 row_mask:0xf bank_mask:0xf bound_ctrl:0
  v_and_b32_dpp v225, v8, v17 row_shl:2 row_mask:0xf bank_mask:0xf bound_ctrl:0
  v_and_b32 v226, v8, v18
  v_and_b32_dpp v227, v8, v19 row_shr:2 row_mask:0xf bank_mask:0xf bound_ctrl:0
  ds_read_b128 v[56:59], v30 offset:14336
  ds_read_b128 v[60:63], v30 offset:15360
  s_waitcnt lgkmcnt(4)
  v_mfma_f32_16x16x32_bf16 v[20:23], v[228:231], v[40:43], v[20:23]
  v_mfma_f32_16x16x32_bf16 v[24:27], v[228:231], v[44:47], v[24:27]
  s_waitcnt vmcnt(9)
  global_load_dwordx4 v[156:159], v[28:29], off
  v_add_co_u32 v28, s[14:15], s72, v28
  s_nop 1
  v_addc_co_u32 v29, s[14:15], 0, v29, s[14:15]
  v_and_b32_dpp v228, v8, v16 row_shl:6 row_mask:0xf bank_mask:0xf bound_ctrl:0
  v_and_b32_dpp v229, v8, v17 row_shl:4 row_mask:0xf bank_mask:0xf bound_ctrl:0
  v_and_b32_dpp v230, v8, v18 row_shl:2 row_mask:0xf bank_mask:0xf bound_ctrl:0
  v_and_b32 v231, v8, v19
  ds_read_b128 v[32:35], v30 offset:16384
  ds_read_b128 v[36:39], v30 offset:17408
  s_waitcnt lgkmcnt(4)
  v_mfma_f32_16x16x32_bf16 v[20:23], v[224:227], v[48:51], v[20:23]
  v_mfma_f32_16x16x32_bf16 v[24:27], v[224:227], v[52:55], v[24:27]
  s_waitcnt vmcnt(9)
  global_load_dwordx4 v[160:163], v[28:29], off
  v_add_co_u32 v28, s[14:15], s72, v28
  s_nop 1
  v_addc_co_u32 v29, s[14:15], 0, v29, s[14:15]
  v_and_b32 v224, v9, v16
  v_and_b32_dpp v225, v9, v17 row_shr:2 row_mask:0xf bank_mask:0xf bound_ctrl:0
  v_and_b32_dpp v226, v9, v18 row_shr:4 row_mask:0xf bank_mask:0xf bound_ctrl:0
  v_and_b32_dpp v227, v9, v19 row_shr:6 row_mask:0xf bank_mask:0xf bound_ctrl:0
  ds_read_b128 v[40:43], v30 offset:18432
  ds_read_b128 v[44:47], v30 offset:19456
  s_waitcnt lgkmcnt(4)
  v_mfma_f32_16x16x32_bf16 v[20:23], v[228:231], v[56:59], v[20:23]
  v_mfma_f32_16x16x32_bf16 v[24:27], v[228:231], v[60:63], v[24:27]
  s_waitcnt vmcnt(9)
  global_load_dwordx4 v[164:167], v[28:29], off
  v_add_co_u32 v28, s[14:15], s72, v28
  s_nop 1
  v_addc_co_u32 v29, s[14:15], 0, v29, s[14:15]
  v_and_b32_dpp v228, v9, v16 row_shl:2 row_mask:0xf bank_mask:0xf bound_ctrl:0
  v_and_b32 v229, v9, v17
  v_and_b32_dpp v230, v9, v18 row_shr:2 row_mask:0xf bank_mask:0xf bound_ctrl:0
  v_and_b32_dpp v231, v9, v19 row_shr:4 row_mask:0xf bank_mask:0xf bound_ctrl:0
  ds_read_b128 v[48:51], v30 offset:20480
  ds_read_b128 v[52:55], v30 offset:21504
  s_waitcnt lgkmcnt(4)
  v_mfma_f32_16x16x32_bf16 v[20:23], v[224:227], v[32:35], v[20:23]
  v_mfma_f32_16x16x32_bf16 v[24:27], v[224:227], v[36:39], v[24:27]
  s_waitcnt vmcnt(9)
  global_load_dwordx4 v[168:171], v[28:29], off
  v_add_co_u32 v28, s[14:15], s72, v28
  s_nop 1
  v_addc_co_u32 v29, s[14:15], 0, v29, s[14:15]
  v_and_b32_dpp v224, v9, v16 row_shl:4 row_mask:0xf bank_mask:0xf bound_ctrl:0
  v_and_b32_dpp v225, v9, v17 row_shl:2 row_mask:0xf bank_mask:0xf bound_ctrl:0
  v_and_b32 v226, v9, v18
  v_and_b32_dpp v227, v9, v19 row_shr:2 row_mask:0xf bank_mask:0xf bound_ctrl:0
  ds_read_b128 v[56:59], v30 offset:22528
  ds_read_b128 v[60:63], v30 offset:23552
  s_waitcnt lgkmcnt(4)
  v_mfma_f32_16x16x32_bf16 v[20:23], v[228:231], v[40:43], v[20:23]
  v_mfma_f32_16x16x32_bf16 v[24:27], v[228:231], v[44:47], v[24:27]
  s_waitcnt vmcnt(9)
  global_load_dwordx4 v[172:175], v[28:29], off
  v_add_co_u32 v28, s[14:15], s72, v28
  s_nop 1
  v_addc_co_u32 v29, s[14:15], 0, v29, s[14:15]
  v_and_b32_dpp v228, v9, v16 row_shl:6 row_mask:0xf bank_mask:0xf bound_ctrl:0
  v_and_b32_dpp v229, v9, v17 row_shl:4 row_mask:0xf bank_mask:0xf bound_ctrl:0
  v_and_b32_dpp v230, v9, v18 row_shl:2 row_mask:0xf bank_mask:0xf bound_ctrl:0
  v_and_b32 v231, v9, v19
  ds_read_b128 v[32:35], v30 offset:24576
  ds_read_b128 v[36:39], v30 offset:25600
  s_waitcnt lgkmcnt(4)
  v_mfma_f32_16x16x32_bf16 v[20:23], v[224:227], v[48:51], v[20:23]
  v_mfma_f32_16x16x32_bf16 v[24:27], v[224:227], v[52:55], v[24:27]
  s_waitcnt vmcnt(9)
  global_load_dwordx4 v[176:179], v[28:29], off
  v_add_co_u32 v28, s[14:15], s72, v28
  s_nop 1
  v_addc_co_u32 v29, s[14:15], 0, v29, s[14:15]
  v_and_b32 v224, v10, v16
  v_and_b32_dpp v225, v10, v17 row_shr:2 row_mask:0xf bank_mask:0xf bound_ctrl:0
  v_and_b32_dpp v226, v10, v18 row_shr:4 row_mask:0xf bank_mask:0xf bound_ctrl:0
  v_and_b32_dpp v227, v10, v19 row_shr:6 row_mask:0xf bank_mask:0xf bound_ctrl:0
  ds_read_b128 v[40:43], v30 offset:26624
  ds_read_b128 v[44:47], v30 offset:27648
  s_waitcnt lgkmcnt(4)
  v_mfma_f32_16x16x32_bf16 v[20:23], v[228:231], v[56:59], v[20:23]
  v_mfma_f32_16x16x32_bf16 v[24:27], v[228:231], v[60:63], v[24:27]
  s_waitcnt vmcnt(9)
  global_load_dwordx4 v[180:183], v[28:29], off
  v_add_co_u32 v28, s[14:15], s72, v28
  s_nop 1
  v_addc_co_u32 v29, s[14:15], 0, v29, s[14:15]
  v_and_b32_dpp v228, v10, v16 row_shl:2 row_mask:0xf bank_mask:0xf bound_ctrl:0
  v_and_b32 v229, v10, v17
  v_and_b32_dpp v230, v10, v18 row_shr:2 row_mask:0xf bank_mask:0xf bound_ctrl:0
  v_and_b32_dpp v231, v10, v19 row_shr:4 row_mask:0xf bank_mask:0xf bound_ctrl:0
  ds_read_b128 v[48:51], v30 offset:28672
  ds_read_b128 v[52:55], v30 offset:29696
  s_waitcnt lgkmcnt(4)
  v_mfma_f32_16x16x32_bf16 v[20:23], v[224:227], v[32:35], v[20:23]
  v_mfma_f32_16x16x32_bf16 v[24:27], v[224:227], v[36:39], v[24:27]
  s_waitcnt vmcnt(9)
  global_load_dwordx4 v[184:187], v[28:29], off
  v_add_co_u32 v28, s[14:15], s72, v28
  s_nop 1
  v_addc_co_u32 v29, s[14:15], 0, v29, s[14:15]
  v_and_b32_dpp v224, v10, v16 row_shl:4 row_mask:0xf bank_mask:0xf bound_ctrl:0
  v_and_b32_dpp v225, v10, v17 row_shl:2 row_mask:0xf bank_mask:0xf bound_ctrl:0
  v_and_b32 v226, v10, v18
  v_and_b32_dpp v227, v10, v19 row_shr:2 row_mask:0xf bank_mask:0xf bound_ctrl:0
  ds_read_b128 v[56:59], v30 offset:30720
  ds_read_b128 v[60:63], v30 offset:31744
  s_waitcnt lgkmcnt(4)
  v_mfma_f32_16x16x32_bf16 v[20:23], v[228:231], v[40:43], v[20:23]
  v_mfma_f32_16x16x32_bf16 v[24:27], v[228:231], v[44:47], v[24:27]
  s_waitcnt vmcnt(9)
  global_load_dwordx4 v[188:191], v[28:29], off
  v_add_co_u32 v28, s[14:15], s72, v28
  s_nop 1
  v_addc_co_u32 v29, s[14:15], 0, v29, s[14:15]
  v_and_b32_dpp v228, v10, v16 row_shl:6 row_mask:0xf bank_mask:0xf bound_ctrl:0
  v_and_b32_dpp v229, v10, v17 row_shl:4 row_mask:0xf bank_mask:0xf bound_ctrl:0
  v_and_b32_dpp v230, v10, v18 row_shl:2 row_mask:0xf bank_mask:0xf bound_ctrl:0
  v_and_b32 v231, v10, v19
  s_waitcnt lgkmcnt(2)
  v_mfma_f32_16x16x32_bf16 v[20:23], v[224:227], v[48:51], v[20:23]
  v_mfma_f32_16x16x32_bf16 v[24:27], v[224:227], v[52:55], v[24:27]
  v_and_b32 v224, v11, v16
  v_and_b32_dpp v225, v11, v17 row_shr:2 row_mask:0xf bank_mask:0xf bound_ctrl:0
  v_and_b32_dpp v226, v11, v18 row_shr:4 row_mask:0xf bank_mask:0xf bound_ctrl:0
  v_and_b32_dpp v227, v11, v19 row_shr:6 row_mask:0xf bank_mask:0xf bound_ctrl:0
  s_waitcnt lgkmcnt(0)
  v_mfma_f32_16x16x32_bf16 v[20:23], v[228:231], v[56:59], v[20:23]
  v_mfma_f32_16x16x32_bf16 v[24:27], v[228:231], v[60:63], v[24:27]
  v_and_b32_dpp v228, v11, v16 row_shl:2 row_mask:0xf bank_mask:0xf bound_ctrl:0
  v_and_b32 v229, v11, v17
  v_and_b32_dpp v230, v11, v18 row_shr:2 row_mask:0xf bank_mask:0xf bound_ctrl:0
  v_and_b32_dpp v231, v11, v19 row_shr:4 row_mask:0xf bank_mask:0xf bound_ctrl:0
  s_waitcnt vmcnt(30)
  v_mfma_f32_16x16x32_bf16 v[20:23], v[224:227], v[64:67], v[20:23]
  v_mfma_f32_16x16x32_bf16 v[24:27], v[224:227], v[68:71], v[24:27]
  s_waitcnt vmcnt(9)
  buffer_load_dwordx4 v[64:67], v3, s[56:59], s71 offen offset:0 nt
  s_waitcnt vmcnt(9)
  buffer_load_dwordx4 v[68:71], v3, s[56:59], s71 offen offset:256 nt
  v_and_b32_dpp v224, v11, v16 row_shl:4 row_mask:0xf bank_mask:0xf bound_ctrl:0
  v_and_b32_dpp v225, v11, v17 row_shl:2 row_mask:0xf bank_mask:0xf bound_ctrl:0
  v_and_b32 v226, v11, v18
  v_and_b32_dpp v227, v11, v19 row_shr:2 row_mask:0xf bank_mask:0xf bound_ctrl:0
  s_waitcnt vmcnt(30)
  v_mfma_f32_16x16x32_bf16 v[20:23], v[228:231], v[72:75], v[20:23]
  v_mfma_f32_16x16x32_bf16 v[24:27], v[228:231], v[76:79], v[24:27]
  s_waitcnt vmcnt(9)
  buffer_load_dwordx4 v[72:75], v3, s[56:59], s71 offen offset:2048 nt
  s_waitcnt vmcnt(9)
  buffer_load_dwordx4 v[76:79], v3, s[56:59], s71 offen offset:2304 nt
  s_add_u32 s71, s71, 16384
  s_and_b32 s71, s71, 0x3ffff
  v_and_b32_dpp v228, v11, v16 row_shl:6 row_mask:0xf bank_mask:0xf bound_ctrl:0
  v_and_b32_dpp v229, v11, v17 row_shl:4 row_mask:0xf bank_mask:0xf bound_ctrl:0
  v_and_b32_dpp v230, v11, v18 row_shl:2 row_mask:0xf bank_mask:0xf bound_ctrl:0
  v_and_b32 v231, v11, v19
  s_waitcnt vmcnt(30)
  v_mfma_f32_16x16x32_bf16 v[20:23], v[224:227], v[80:83], v[20:23]
  v_mfma_f32_16x16x32_bf16 v[24:27], v[224:227], v[84:87], v[24:27]
  s_waitcnt vmcnt(9)
  buffer_load_dwordx4 v[80:83], v3, s[56:59], s71 offen offset:0 nt
  s_waitcnt vmcnt(9)
  buffer_load_dwordx4 v[84:87], v3, s[56:59], s71 offen offset:256 nt
  v_and_b32 v224, v12, v16
  v_and_b32_dpp v225, v12, v17 row_shr:2 row_mask:0xf bank_mask:0xf bound_ctrl:0
  v_and_b32_dpp v226, v12, v18 row_shr:4 row_mask:0xf bank_mask:0xf bound_ctrl:0
  v_and_b32_dpp v227, v12, v19 row_shr:6 row_mask:0xf bank_mask:0xf bound_ctrl:0
  s_waitcnt vmcnt(30)
  v_mfma_f32_16x16x32_bf16 v[20:23], v[228:231], v[88:91], v[20:23]
  v_mfma_f32_16x16x32_bf16 v[24:27], v[228:231], v[92:95], v[24:27]
  s_waitcnt vmcnt(9)
  buffer_load_dwordx4 v[88:91], v3, s[56:59], s71 offen offset:2048 nt
  s_waitcnt vmcnt(9)
  buffer_load_dwordx4 v[92:95], v3, s[56:59], s71 offen offset:2304 nt
  s_add_u32 s71, s71, 16384
  s_and_b32 s71, s71, 0x3ffff
  v_and_b32_dpp v228, v12, v16 row_shl:2 row_mask:0xf bank_mask:0xf bound_ctrl:0
  v_and_b32 v229, v12, v17
  v_and_b32_dpp v230, v12, v18 row_shr:2 row_mask:0xf bank_mask:0xf bound_ctrl:0
  v_and_b32_dpp v231, v12, v19 row_shr:4 row_mask:0xf bank_mask:0xf bound_ctrl:0
  s_waitcnt vmcnt(30)
  v_mfma_f32_16x16x32_bf16 v[20:23], v[224:227], v[96:99], v[20:23]
  v_mfma_f32_16x16x32_bf16 v[24:27], v[224:227], v[100:103], v[24:27]
  s_waitcnt vmcnt(9)
  buffer_load_dwordx4 v[96:99], v3, s[56:59], s71 offen offset:0 nt
  s_waitcnt vmcnt(9)
  buffer_load_dwordx4 v[100:103], v3, s[56:59], s71 offen offset:256 nt
  v_and_b32_dpp v224, v12, v16 row_shl:4 row_mask:0xf bank_mask:0xf bound_ctrl:0
  v_and_b32_dpp v225, v12, v17 row_shl:2 row_mask:0xf bank_mask:0xf bound_ctrl:0
  v_and_b32 v226, v12, v18
  v_and_b32_dpp v227, v12, v19 row_shr:2 row_mask:0xf bank_mask:0xf bound_ctrl:0
  s_waitcnt vmcnt(30)
  v_mfma_f32_16x16x32_bf16 v[20:23], v[228:231], v[104:107], v[20:23]
  v_mfma_f32_16x16x32_bf16 v[24:27], v[228:231], v[108:111], v[24:27]
  s_waitcnt vmcnt(9)
  buffer_load_dwordx4 v[104:107], v3, s[56:59], s71 offen offset:2048 nt
  s_waitcnt vmcnt(9)
  buffer_load_dwordx4 v[108:111], v3, s[56:59], s71 offen offset:2304 nt
  s_add_u32 s71, s71, 16384
  s_and_b32 s71, s71, 0x3ffff
  v_and_b32_dpp v228, v12, v16 row_shl:6 row_mask:0xf bank_mask:0xf bound_ctrl:0
  v_and_b32_dpp v229, v12, v17 row_shl:4 row_mask:0xf bank_mask:0xf bound_ctrl:0
  v_and_b32_dpp v230, v12, v18 row_shl:2 row_mask:0xf bank_mask:0xf bound_ctrl:0
  v_and_b32 v231, v12, v19
  s_waitcnt vmcnt(30)
  v_mfma_f32_16x16x32_bf16 v[20:23], v[224:227], v[112:115], v[20:23]
  v_mfma_f32_16x16x32_bf16 v[24:27], v[224:227], v[116:119], v[24:27]
  s_waitcnt vmcnt(9)
  buffer_load_dwordx4 v[112:115], v3, s[56:59], s71 offen offset:0 nt
  s_waitcnt vmcnt(9)
  buffer_load_dwordx4 v[116:119], v3, s[56:59], s71 offen offset:256 nt
  v_and_b32 v224, v13, v16
  v_and_b32_dpp v225, v13, v17 row_shr:2 row_mask:0xf bank_mask:0xf bound_ctrl:0
  v_and_b32_dpp v226, v13, v18 row_shr:4 row_mask:0xf bank_mask:0xf bound_ctrl:0
  v_and_b32_dpp v227, v13, v19 row_shr:6 row_mask:0xf bank_mask:0xf bound_ctrl:0
  s_waitcnt vmcnt(30)
  v_mfma_f32_16x16x32_bf16 v[20:23], v[228:231], v[120:123], v[20:23]
  v_mfma_f32_16x16x32_bf16 v[24:27], v[228:231], v[124:127], v[24:27]
  s_waitcnt vmcnt(9)
  buffer_load_dwordx4 v[120:123], v3, s[56:59], s71 offen offset:2048 nt
  s_waitcnt vmcnt(9)
  buffer_load_dwordx4 v[124:127], v3, s[56:59], s71 offen offset:2304 nt
  s_add_u32 s71, s71, 16384
  s_and_b32 s71, s71, 0x3ffff
  v_and_b32_dpp v228, v13, v16 row_shl:2 row_mask:0xf bank_mask:0xf bound_ctrl:0
  v_and_b32 v229, v13, v17
  v_and_b32_dpp v230, v13, v18 row_shr:2 row_mask:0xf bank_mask:0xf bound_ctrl:0
  v_and_b32_dpp v231, v13, v19 row_shr:4 row_mask:0xf bank_mask:0xf bound_ctrl:0
  s_waitcnt vmcnt(14)
  v_mfma_f32_16x16x32_bf16 v[20:23], v[224:227], v[64:67], v[20:23]
  v_mfma_f32_16x16x32_bf16 v[24:27], v[224:227], v[68:71], v[24:27]
  s_waitcnt vmcnt(9)
  buffer_load_dwordx4 v[64:67], v3, s[56:59], s71 offen offset:0 nt
  s_waitcnt vmcnt(9)
  buffer_load_dwordx4 v[68:71], v3, s[56:59], s71 offen offset:256 nt
  v_and_b32_dpp v224, v13, v16 row_shl:4 row_mask:0xf bank_mask:0xf bound_ctrl:0
  v_and_b32_dpp v225, v13, v17 row_shl:2 row_mask:0xf bank_mask:0xf bound_ctrl:0
  v_and_b32 v226, v13, v18
  v_and_b32_dpp v227, v13, v19 row_shr:2 row_mask:0xf bank_mask:0xf bound_ctrl:0
  s_waitcnt vmcnt(14)
  v_mfma_f32_16x16x32_bf16 v[20:23], v[228:231], v[72:75], v[20:23]
  v_mfma_f32_16x16x32_bf16 v[24:27], v[228:231], v[76:79], v[24:27]
  s_waitcnt vmcnt(9)
  buffer_load_dwordx4 v[72:75], v3, s[56:59], s71 offen offset:2048 nt
  s_waitcnt vmcnt(9)
  buffer_load_dwordx4 v[76:79], v3, s[56:59], s71 offen offset:2304 nt
  s_add_u32 s71, s71, 16384
  s_and_b32 s71, s71, 0x3ffff
  v_and_b32_dpp v228, v13, v16 row_shl:6 row_mask:0xf bank_mask:0xf bound_ctrl:0
  v_and_b32_dpp v229, v13, v17 row_shl:4 row_mask:0xf bank_mask:0xf bound_ctrl:0
  v_and_b32_dpp v230, v13, v18 row_shl:2 row_mask:0xf bank_mask:0xf bound_ctrl:0
  v_and_b32 v231, v13, v19
  s_waitcnt vmcnt(14)
  v_mfma_f32_16x16x32_bf16 v[20:23], v[224:227], v[80:83], v[20:23]
  v_mfma_f32_16x16x32_bf16 v[24:27], v[224:227], v[84:87], v[24:27]
  s_waitcnt vmcnt(9)
  buffer_load_dwordx4 v[80:83], v3, s[56:59], s71 offen offset:0 nt
  s_waitcnt vmcnt(9)
  buffer_load_dwordx4 v[84:87], v3, s[56:59], s71 offen offset:256 nt
  v_and_b32 v224, v14, v16
  v_and_b32_dpp v225, v14, v17 row_shr:2 row_mask:0xf bank_mask:0xf bound_ctrl:0
  v_and_b32_dpp v226, v14, v18 row_shr:4 row_mask:0xf bank_mask:0xf bound_ctrl:0
  v_and_b32_dpp v227, v14, v19 row_shr:6 row_mask:0xf bank_mask:0xf bound_ctrl:0
  s_waitcnt vmcnt(14)
  v_mfma_f32_16x16x32_bf16 v[20:23], v[228:231], v[88:91], v[20:23]
  v_mfma_f32_16x16x32_bf16 v[24:27], v[228:231], v[92:95], v[24:27]
  s_waitcnt vmcnt(9)
  buffer_load_dwordx4 v[88:91], v3, s[56:59], s71 offen offset:2048 nt
  s_waitcnt vmcnt(9)
  buffer_load_dwordx4 v[92:95], v3, s[56:59], s71 offen offset:2304 nt
  v_and_b32_dpp v228, v14, v16 row_shl:2 row_mask:0xf bank_mask:0xf bound_ctrl:0
  v_and_b32 v229, v14, v17
  v_and_b32_dpp v230, v14, v18 row_shr:2 row_mask:0xf bank_mask:0xf bound_ctrl:0
  v_and_b32_dpp v231, v14, v19 row_shr:4 row_mask:0xf bank_mask:0xf bound_ctrl:0
  s_waitcnt vmcnt(14)
  v_mfma_f32_16x16x32_bf16 v[20:23], v[224:227], v[96:99], v[20:23]
  v_mfma_f32_16x16x32_bf16 v[24:27], v[224:227], v[100:103], v[24:27]
  v_lshrrev_b32 v4, 4, v1
  v_bfe_u32 v5, v1, 3, 1
  v_and_b32 v6, 7, v1
  s_cmp_lt_u32 s47, 28
  s_cbranch_scc1 L_tsfs
  v_lshlrev_b32 v192, 17, v5
  v_lshl_add_u32 v192, v4, 10, v192
  v_lshl_add_u32 v192, v6, 4, v192
  v_lshlrev_b32 v193, 12, v5
  v_lshl_add_u32 v193, v4, 7, v193
  s_lshl_b32 s13, s4, 3
  s_add_u32 s13, s13, s6
  s_lshl_b32 s76, s13, 14
  s_lshl_b32 s14, s8, 12
  s_add_u32 s76, s76, s14
  s_add_u32 s76, s76, 1049088
  s_lshl_b32 s77, s13, 9
  s_add_u32 s77, s77, 32784
  s_lshl_b32 s70, s4, 4
  s_lshl_b32 s14, s6, 2
  s_add_u32 s70, s70, s14
  s_add_u32 s70, s70, s5
  s_lshl_b32 s70, s70, 2
  s_add_u32 s70, s70, 1024
  v_lshrrev_b32 v194, 1, v4
  v_lshlrev_b32 v194, 9, v194
  v_and_b32 v7, 15, v1
  v_lshl_add_u32 v194, v7, 5, v194
  v_and_b32 v7, 1, v4
  v_lshl_add_u32 v194, v7, 4, v194
  s_lshl_b32 s14, s3, 10
  v_add_u32 v194, s14, v194
  s_branch L_tsjs
L_tsfs:
  s_lshl_b32 s13, s8, 6
  v_mov_b32 v7, v6
  s_mov_b64 s[74:75], -1
  v_lshlrev_b32 v192, 14, v5
  v_lshl_add_u32 v192, v4, 11, v192
  v_lshl_add_u32 v193, v7, 4, v192
  v_add_u32 v193, 128, v193
  v_lshl_add_u32 v192, v6, 4, v192
  s_sub_u32 s14, s4, 1
  s_lshl_b32 s76, s14, 14
  s_lshl_b32 s14, s13, 2
  s_add_u32 s76, s76, s14
  s_add_u32 s76, s76, 131072
  s_add_u32 s77, s76, 0x2000
  v_add_u32 v194, s13, v4
  v_lshl_add_u32 v195, v7, 2, v194
  v_add_u32 v195, 32, v195
  v_lshl_add_u32 v194, v6, 2, v194
  v_lshlrev_b32 v196, 13, v5
  v_lshl_add_u32 v197, v7, 4, v196
  v_add_u32 v197, 128, v197
  v_lshl_add_u32 v196, v6, 4, v196
  s_sub_u32 s14, s4, 1
  s_lshl_b32 s15, s14, 13
  s_lshl_b32 s13, s13, 2
  s_add_u32 s15, s15, s13
  s_add_u32 s67, s15, 65536
  s_mul_i32 s14, s14, 896
  s_add_u32 s64, s16, s14
  s_addc_u32 s65, s17, 0
  v_mul_u32_u24 v7, 448, v5
  v_add_lshl_u32 v194, v194, v7, 1
  v_add_lshl_u32 v195, v195, v7, 1
  v_mul_u32_u24 v201, 0x0202, v4
  v_add_u32 v201, 0x0100, v201
  v_lshlrev_b32 v201, 16, v201
  v_or_b32 v201, 0x0c0c, v201
  v_lshrrev_b32 v198, 1, v4
  v_lshlrev_b32 v198, 7, v198
  v_lshl_add_u32 v198, v5, 3, v198
  v_lshl_add_u32 v198, v6, 4, v198
  v_and_b32 v7, 1, v4
  v_lshl_add_u32 v198, v7, 9, v198
  s_lshl_b32 s14, s3, 10
  s_add_u32 s14, s14, 4096
  v_add_u32 v198, s14, v198
  v_lshlrev_b32 v200, 6, v5
  v_lshl_add_u32 v199, v7, 2, v200
  s_lshl_b32 s14, s3, 3
  v_add_u32 v199, s14, v199
  v_bfe_u32 v4, v1, 2, 1
  v_lshlrev_b32 v4, 4, v4
  v_mov_b32 v5, 0x3f80
  v_lshlrev_b32 v4, v4, v5
  v_and_b32 v5, 11, v1
  v_cmp_eq_u32 vcc, 0, v5
  s_nop 1
  v_cndmask_b32 v204, 0, v4, vcc
  v_mov_b32 v205, 0
  v_cmp_eq_u32 vcc, 8, v5
  s_nop 1
  v_cndmask_b32 v206, 0, v4, vcc
  v_mov_b32 v207, 0
  v_cmp_eq_u32 vcc, 1, v5
  s_nop 1
  v_cndmask_b32 v208, 0, v4, vcc
  v_mov_b32 v209, 0
  v_cmp_eq_u32 vcc, 9, v5
  s_nop 1
  v_cndmask_b32 v210, 0, v4, vcc
  v_mov_b32 v211, 0
  v_mov_b32 v212, 0
  v_mov_b32 v213, 0
  s_lshr_b32 s13, s7, 2
  s_lshl_b32 s13, s13, 13
  s_add_u32 s70, s76, s13
  s_and_b32 s13, s7, 3
  s_lshl_b32 s13, s13, 4
  s_lshl_b64 s[68:69], 0xffff, s13
L_tsjs:
  s_lshl_b32 s13, s3, 11
  v_add_u32 v30, s13, v31
  v_and_b32_dpp v224, v14, v16 row_shl:4 row_mask:0xf bank_mask:0xf bound_ctrl:0
  v_and_b32_dpp v225, v14, v17 row_shl:2 row_mask:0xf bank_mask:0xf bound_ctrl:0
  v_and_b32 v226, v14, v18
  v_and_b32_dpp v227, v14, v19 row_shr:2 row_mask:0xf bank_mask:0xf bound_ctrl:0
  s_waitcnt vmcnt(12)
  v_mfma_f32_16x16x32_bf16 v[20:23], v[228:231], v[104:107], v[20:23]
  v_mfma_f32_16x16x32_bf16 v[24:27], v[228:231], v[108:111], v[24:27]
  v_and_b32_dpp v228, v14, v16 row_shl:6 row_mask:0xf bank_mask:0xf bound_ctrl:0
  v_and_b32_dpp v229, v14, v17 row_shl:4 row_mask:0xf bank_mask:0xf bound_ctrl:0
  v_and_b32_dpp v230, v14, v18 row_shl:2 row_mask:0xf bank_mask:0xf bound_ctrl:0
  v_and_b32 v231, v14, v19
  s_waitcnt vmcnt(10)
  v_mfma_f32_16x16x32_bf16 v[20:23], v[224:227], v[112:115], v[20:23]
  v_mfma_f32_16x16x32_bf16 v[24:27], v[224:227], v[116:119], v[24:27]
  v_and_b32 v224, v15, v16
  v_and_b32_dpp v225, v15, v17 row_shr:2 row_mask:0xf bank_mask:0xf bound_ctrl:0
  v_and_b32_dpp v226, v15, v18 row_shr:4 row_mask:0xf bank_mask:0xf bound_ctrl:0
  v_and_b32_dpp v227, v15, v19 row_shr:6 row_mask:0xf bank_mask:0xf bound_ctrl:0
  s_waitcnt vmcnt(8)
  v_mfma_f32_16x16x32_bf16 v[20:23], v[228:231], v[120:123], v[20:23]
  v_mfma_f32_16x16x32_bf16 v[24:27], v[228:231], v[124:127], v[24:27]
  v_and_b32_dpp v228, v15, v16 row_shl:2 row_mask:0xf bank_mask:0xf bound_ctrl:0
  v_and_b32 v229, v15, v17
  v_and_b32_dpp v230, v15, v18 row_shr:2 row_mask:0xf bank_mask:0xf bound_ctrl:0
  v_and_b32_dpp v231, v15, v19 row_shr:4 row_mask:0xf bank_mask:0xf bound_ctrl:0
  s_waitcnt vmcnt(6)
  v_mfma_f32_16x16x32_bf16 v[20:23], v[224:227], v[64:67], v[20:23]
  v_mfma_f32_16x16x32_bf16 v[24:27], v[224:227], v[68:71], v[24:27]
  v_and_b32_dpp v224, v15, v16 row_shl:4 row_mask:0xf bank_mask:0xf bound_ctrl:0
  v_and_b32_dpp v225, v15, v17 row_shl:2 row_mask:0xf bank_mask:0xf bound_ctrl:0
  v_and_b32 v226, v15, v18
  v_and_b32_dpp v227, v15, v19 row_shr:2 row_mask:0xf bank_mask:0xf bound_ctrl:0
  s_waitcnt vmcnt(4)
  v_mfma_f32_16x16x32_bf16 v[20:23], v[228:231], v[72:75], v[20:23]
  v_mfma_f32_16x16x32_bf16 v[24:27], v[228:231], v[76:79], v[24:27]
  v_and_b32_dpp v228, v15, v16 row_shl:6 row_mask:0xf bank_mask:0xf bound_ctrl:0
  v_and_b32_dpp v229, v15, v17 row_shl:4 row_mask:0xf bank_mask:0xf bound_ctrl:0
  v_and_b32_dpp v230, v15, v18 row_shl:2 row_mask:0xf bank_mask:0xf bound_ctrl:0
  v_and_b32 v231, v15, v19
  s_waitcnt vmcnt(2)
  v_mfma_f32_16x16x32_bf16 v[20:23], v[224:227], v[80:83], v[20:23]
  v_mfma_f32_16x16x32_bf16 v[24:27], v[224:227], v[84:87], v[24:27]
  s_waitcnt vmcnt(0)
  v_mfma_f32_16x16x32_bf16 v[20:23], v[228:231], v[88:91], v[20:23]
  v_mfma_f32_16x16x32_bf16 v[24:27], v[228:231], v[92:95], v[24:27]
  s_nop 6
  ds_write_b128 v30, v[20:23] offset:19712
  ds_write_b128 v30, v[24:27] offset:20736
  s_waitcnt lgkmcnt(0)
  s_barrier
  s_branch L_tail_s
L_helper:
  v_lshlrev_b32 v2, 4, v1
  v_lshrrev_b32 v3, 4, v1
  v_bfe_u32 v5, v1, 1, 3
  v_and_b32 v6, 1, v1
  v_lshlrev_b32 v6, 4, v6
  v_lshl_add_u32 v6, v3, 5, v6
  v_lshl_add_u32 v7, v5, 13, v6
  v_mul_u32_u24 v5, 5376, v5
  v_add_u32 v6, v5, v6
  v_and_b32 v4, 15, v1
  s_mov_b32 s85, 0
  s_or_b32 s13, s9, s12
  s_cbranch_scc0 L_noprio
  s_setprio 3
L_noprio:
  s_mov_b32 s50, 3145728
  s_mov_b32 s51, 0x20000
  s_mov_b32 s54, 2408448
  s_mov_b32 s55, 0x20000
  s_mov_b32 s58, 3670016
  s_mov_b32 s59, 0x20000
  v_mov_b32 v8, 0
  v_mov_b32 v9, 0
  v_mov_b32 v10, 0
  v_mov_b32 v11, 0
  ds_write_b128 v8, v[8:11] offset:0
  ds_write_b64 v8, v[8:9] offset:16
  s_waitcnt lgkmcnt(0)
  s_load_dword s44, s[42:43], 0
  s_barrier
  s_mov_b32 s48, s42
  s_mov_b32 s49, s43
  s_mov_b32 s52, s36
  s_mov_b32 s53, s37
  s_mov_b32 s56, s22
  s_mov_b32 s57, s23
  s_cmp_lg_u32 s9, 0
  s_cbranch_scc1 L_p1
  s_cmp_lg_u32 s8, 2
  s_cbranch_scc1 L_np2
  s_lshr_b32 s13, s2, 3
  s_mul_i32 s13, s13, 14
  v_lshrrev_b32 v16, 1, v1
  v_add_u32 v16, s13, v16
  v_mul_u32_u24 v16, 5376, v16
  v_and_b32 v17, 1, v1
  v_mul_u32_u24 v17, 896, v17
  s_lshl_b32 s13, s6, 7
  v_add3_u32 v16, v16, v17, s13
  s_mov_b64 exec, 0xfffffff
  buffer_load_dword v60, v16, s[52:55], 0 offen
  s_mov_b64 exec, -1
  s_lshr_b32 s13, s2, 3
  s_cmp_ge_u32 s13, 26
  s_cbranch_scc1 L_nopfa
  s_getpc_b64 s[14:15]
L_pca:
  s_sub_u32 s14, s14, L_pca-L_start
  s_subb_u32 s15, s15, 0
  s_lshl_b32 s13, s13, 10
  v_add_u32 v16, s13, v2
  global_load_dwordx4 v[60:63], v16, s[14:15]
L_nopfa:
L_np2:
  s_cmp_lg_u32 s12, 0
  s_cbranch_scc1 L_p2
  s_branch L_wts
L_p1:
  s_mul_i32 s13, s8, 1792
  v_add_u32 v5, s13, v2
  global_load_dwordx4 v[8:11], v5, s[34:35]
  s_mov_b32 exec_hi, 0xffff
  global_load_dwordx4 v[12:15], v5, s[34:35] offset:1024
  s_mov_b32 exec_hi, -1
  v_and_b32 v16, 7, v1
  v_mul_u32_u24 v16, 896, v16
  v_lshl_add_u32 v16, v3, 3, v16
  s_lshl_b32 s13, s6, 7
  s_lshl_b32 s14, s8, 5
  s_add_u32 s13, s13, s14
  s_cmp_eq_u32 s9, 1
  s_cselect_b32 s13, s13, 0
  v_add_u32 v16, s13, v16
  global_load_dwordx2 v[18:19], v16, s[16:17]
  v_lshrrev_b32 v16, 3, v1
  v_mul_u32_u24 v16, 896, v16
  v_and_b32 v17, 7, v1
  v_lshl_add_u32 v16, v17, 4, v16
  s_cmp_lg_u32 s8, 2
  s_cbranch_scc1 L_nox
  global_load_dwordx4 v[64:67], v16, s[16:17] offset:0
  global_load_dwordx4 v[68:71], v16, s[16:17] offset:128
  global_load_dwordx4 v[72:75], v16, s[16:17] offset:256
  global_load_dwordx4 v[76:79], v16, s[16:17] offset:384
  global_load_dwordx4 v[80:83], v16, s[16:17] offset:512
  global_load_dwordx4 v[84:87], v16, s[16:17] offset:640
  global_load_dwordx4 v[88:91], v16, s[16:17] offset:768
L_nox:
  s_lshl_b32 s11, s10, 8
  s_lshl_b32 s13, s10, 7
  s_add_u32 s14, s13, 2304
  s_cmp_eq_u32 s9, 3
  s_cselect_b32 s11, s14, s11
  s_add_u32 s14, s11, 1792
  s_movk_i32 s15, 128
  s_cmp_eq_u32 s9, 1
  s_cselect_b32 s13, s13, s14
  s_cselect_b32 s14, 896, s15
  s_mul_i32 s15, s8, 602112
  s_add_u32 s13, s13, s15
  s_add_u32 s14, s13, s14
  s_mul_i32 s15, s8, 14336
  s_add_u32 m0, s15, 32768
  s_nop 0
  buffer_load_dwordx4 v6, s[52:55], s13 offen  lds
  s_add_u32 s13, s13, 43008
  s_add_u32 m0, s15, 33792
  s_nop 0
  buffer_load_dwordx4 v6, s[52:55], s13 offen  lds
  s_add_u32 s13, s13, 43008
  s_add_u32 m0, s15, 34816
  s_nop 0
  buffer_load_dwordx4 v6, s[52:55], s13 offen  lds
  s_add_u32 s13, s13, 43008
  s_add_u32 m0, s15, 35840
  s_nop 0
  buffer_load_dwordx4 v6, s[52:55], s13 offen  lds
  s_add_u32 s13, s13, 43008
  s_add_u32 m0, s15, 36864
  s_nop 0
  buffer_load_dwordx4 v6, s[52:55], s13 offen  lds
  s_add_u32 s13, s13, 43008
  s_add_u32 m0, s15, 37888
  s_nop 0
  buffer_load_dwordx4 v6, s[52:55], s13 offen  lds
  s_add_u32 s13, s13, 43008
  s_add_u32 m0, s15, 38912
  s_nop 0
  buffer_load_dwordx4 v6, s[52:55], s13 offen  lds
  s_add_u32 s13, s13, 43008
  s_add_u32 m0, s15, 39936
  s_nop 0
  buffer_load_dwordx4 v6, s[52:55], s13 offen  lds
  s_add_u32 s13, s13, 43008
  s_add_u32 m0, s15, 40960
  s_nop 0
  buffer_load_dwordx4 v6, s[52:55], s13 offen  lds
  s_add_u32 s13, s13, 43008
  s_add_u32 m0, s15, 41984
  s_nop 0
  buffer_load_dwordx4 v6, s[52:55], s13 offen  lds
  s_add_u32 s13, s13, 43008
  s_add_u32 m0, s15, 43008
  s_nop 0
  buffer_load_dwordx4 v6, s[52:55], s13 offen  lds
  s_add_u32 s13, s13, 43008
  s_add_u32 m0, s15, 44032
  s_nop 0
  buffer_load_dwordx4 v6, s[52:55], s13 offen  lds
  s_add_u32 s13, s13, 43008
  s_add_u32 m0, s15, 45056
  s_nop 0
  buffer_load_dwordx4 v6, s[52:55], s13 offen  lds
  s_add_u32 s13, s13, 43008
  s_add_u32 m0, s15, 46080
  s_nop 0
  buffer_load_dwordx4 v6, s[52:55], s13 offen  lds
  s_waitcnt vmcnt(14)
  s_cmp_eq_u32 s9, 3
  s_cbranch_scc1 L_onehalf
  s_add_u32 m0, s15, 90112
  s_nop 0
  buffer_load_dwordx4 v6, s[52:55], s14 offen  lds
  s_add_u32 s14, s14, 43008
  s_add_u32 m0, s15, 91136
  s_nop 0
  buffer_load_dwordx4 v6, s[52:55], s14 offen  lds
  s_add_u32 s14, s14, 43008
  s_add_u32 m0, s15, 92160
  s_nop 0
  buffer_load_dwordx4 v6, s[52:55], s14 offen  lds
  s_add_u32 s14, s14, 43008
  s_add_u32 m0, s15, 93184
  s_nop 0
  buffer_load_dwordx4 v6, s[52:55], s14 offen  lds
  s_add_u32 s14, s14, 43008
  s_add_u32 m0, s15, 94208
  s_nop 0
  buffer_load_dwordx4 v6, s[52:55], s14 offen  lds
  s_add_u32 s14, s14, 43008
  s_add_u32 m0, s15, 95232
  s_nop 0
  buffer_load_dwordx4 v6, s[52:55], s14 offen  lds
  s_add_u32 s14, s14, 43008
  s_add_u32 m0, s15, 96256
  s_nop 0
  buffer_load_dwordx4 v6, s[52:55], s14 offen  lds
  s_add_u32 s14, s14, 43008
  s_add_u32 m0, s15, 97280
  s_nop 0
  buffer_load_dwordx4 v6, s[52:55], s14 offen  lds
  s_add_u32 s14, s14, 43008
  s_add_u32 m0, s15, 98304
  s_nop 0
  buffer_load_dwordx4 v6, s[52:55], s14 offen  lds
  s_add_u32 s14, s14, 43008
  s_add_u32 m0, s15, 99328
  s_nop 0
  buffer_load_dwordx4 v6, s[52:55], s14 offen  lds
  s_add_u32 s14, s14, 43008
  s_add_u32 m0, s15, 100352
  s_nop 0
  buffer_load_dwordx4 v6, s[52:55], s14 offen  lds
  s_add_u32 s14, s14, 43008
  s_add_u32 m0, s15, 101376
  s_nop 0
  buffer_load_dwordx4 v6, s[52:55], s14 offen  lds
  s_add_u32 s14, s14, 43008
  s_add_u32 m0, s15, 102400
  s_nop 0
  buffer_load_dwordx4 v6, s[52:55], s14 offen  lds
  s_add_u32 s14, s14, 43008
  s_add_u32 m0, s15, 103424
  s_nop 0
  buffer_load_dwordx4 v6, s[52:55], s14 offen  lds
L_onehalf:
  s_mov_b32 s13, 0xbfb8aa3b
  v_lshlrev_b32 v20, 16, v8
  v_and_b32 v21, s46, v8
  v_mul_f32 v22, s13, v20
  v_mul_f32 v23, s13, v21
  v_exp_f32 v22, v22
  v_exp_f32 v23, v23
  v_lshlrev_b32 v24, 16, v9
  v_and_b32 v25, s46, v9
  v_mul_f32 v26, s13, v24
  v_mul_f32 v27, s13, v25
  v_exp_f32 v26, v26
  v_exp_f32 v27, v27
  v_lshlrev_b32 v28, 16, v10
  v_and_b32 v29, s46, v10
  v_mul_f32 v30, s13, v28
  v_mul_f32 v31, s13, v29
  v_exp_f32 v30, v30
  v_exp_f32 v31, v31
  v_lshlrev_b32 v32, 16, v11
  v_and_b32 v33, s46, v11
  v_mul_f32 v34, s13, v32
  v_mul_f32 v35, s13, v33
  v_exp_f32 v34, v34
  v_exp_f32 v35, v35
  v_lshlrev_b32 v36, 16, v12
  v_and_b32 v37, s46, v12
  v_mul_f32 v38, s13, v36
  v_mul_f32 v39, s13, v37
  v_exp_f32 v38, v38
  v_exp_f32 v39, v39
  v_lshlrev_b32 v40, 16, v13
  v_and_b32 v41, s46, v13
  v_mul_f32 v42, s13, v40
  v_mul_f32 v43, s13, v41
  v_exp_f32 v42, v42
  v_exp_f32 v43, v43
  v_lshlrev_b32 v44, 16, v14
  v_and_b32 v45, s46, v14
  v_mul_f32 v46, s13, v44
  v_mul_f32 v47, s13, v45
  v_exp_f32 v46, v46
  v_exp_f32 v47, v47
  v_lshlrev_b32 v48, 16, v15
  v_and_b32 v49, s46, v15
  v_mul_f32 v50, s13, v48
  v_mul_f32 v51, s13, v49
  v_exp_f32 v50, v50
  v_exp_f32 v51, v51
  v_add_f32 v22, 1.0, v22
  v_add_f32 v23, 1.0, v23
  v_rcp_f32 v22, v22
  v_rcp_f32 v23, v23
  v_add_f32 v26, 1.0, v26
  v_add_f32 v27, 1.0, v27
  v_rcp_f32 v26, v26
  v_rcp_f32 v27, v27
  v_add_f32 v30, 1.0, v30
  v_add_f32 v31, 1.0, v31
  v_rcp_f32 v30, v30
  v_rcp_f32 v31, v31
  v_add_f32 v34, 1.0, v34
  v_add_f32 v35, 1.0, v35
  v_rcp_f32 v34, v34
  v_rcp_f32 v35, v35
  v_add_f32 v38, 1.0, v38
  v_add_f32 v39, 1.0, v39
  v_rcp_f32 v38, v38
  v_rcp_f32 v39, v39
  v_add_f32 v42, 1.0, v42
  v_add_f32 v43, 1.0, v43
  v_rcp_f32 v42, v42
  v_rcp_f32 v43, v43
  v_add_f32 v46, 1.0, v46
  v_add_f32 v47, 1.0, v47
  v_rcp_f32 v46, v46
  v_rcp_f32 v47, v47
  v_add_f32 v50, 1.0, v50
  v_add_f32 v51, 1.0, v51
  v_rcp_f32 v50, v50
  v_rcp_f32 v51, v51
  v_mul_f32 v20, v20, v22
  v_mul_f32 v21, v21, v23
  v_cvt_pk_bf16_f32 v8, v20, v21
  v_mul_f32 v24, v24, v26
  v_mul_f32 v25, v25, v27
  v_cvt_pk_bf16_f32 v9, v24, v25
  v_mul_f32 v28, v28, v30
  v_mul_f32 v29, v29, v31
  v_cvt_pk_bf16_f32 v10, v28, v29
  v_mul_f32 v32, v32, v34
  v_mul_f32 v33, v33, v35
  v_cvt_pk_bf16_f32 v11, v32, v33
  v_mul_f32 v36, v36, v38
  v_mul_f32 v37, v37, v39
  v_cvt_pk_bf16_f32 v12, v36, v37
  v_mul_f32 v40, v40, v42
  v_mul_f32 v41, v41, v43
  v_cvt_pk_bf16_f32 v13, v40, v41
  v_mul_f32 v44, v44, v46
  v_mul_f32 v45, v45, v47
  v_cvt_pk_bf16_f32 v14, v44, v45
  v_mul_f32 v48, v48, v50
  v_mul_f32 v49, v49, v51
  v_cvt_pk_bf16_f32 v15, v48, v49
  s_mul_i32 s13, s8, 1824
  v_add_u32 v16, s13, v2
  v_add_u32 v17, 16, v16
  v_cmp_le_u32 vcc, 56, v1
  s_nop 1
  v_cndmask_b32 v16, v16, v17, vcc
  ds_write_b128 v16, v[8:11] offset:12288
  s_mov_b32 exec_hi, 0xffff
  ds_write_b128 v17, v[12:15] offset:13312
  s_mov_b32 exec_hi, -1
  s_cmp_lg_u32 s8, 2
  s_cbranch_scc1 L_nostat
  v_mov_b32 v20, 0
  v_mov_b32 v21, 0
  v_mov_b32 v22, 0
  v_mov_b32 v23, 0
  v_mov_b32 v24, 0x3f803f80
  v_dot2c_f32_bf16 v20, v64, v24
  v_dot2c_f32_bf16 v21, v64, v64
  v_dot2c_f32_bf16 v22, v65, v24
  v_dot2c_f32_bf16 v23, v65, v65
  v_dot2c_f32_bf16 v20, v66, v24
  v_dot2c_f32_bf16 v21, v66, v66
  v_dot2c_f32_bf16 v22, v67, v24
  v_dot2c_f32_bf16 v23, v67, v67
  v_dot2c_f32_bf16 v20, v68, v24
  v_dot2c_f32_bf16 v21, v68, v68
  v_dot2c_f32_bf16 v22, v69, v24
  v_dot2c_f32_bf16 v23, v69, v69
  v_dot2c_f32_bf16 v20, v70, v24
  v_dot2c_f32_bf16 v21, v70, v70
  v_dot2c_f32_bf16 v22, v71, v24
  v_dot2c_f32_bf16 v23, v71, v71
  v_dot2c_f32_bf16 v20, v72, v24
  v_dot2c_f32_bf16 v21, v72, v72
  v_dot2c_f32_bf16 v22, v73, v24
  v_dot2c_f32_bf16 v23, v73, v73
  v_dot2c_f32_bf16 v20, v74, v24
  v_dot2c_f32_bf16 v21, v74, v74
  v_dot2c_f32_bf16 v22, v75, v24
  v_dot2c_f32_bf16 v23, v75, v75
  v_dot2c_f32_bf16 v20, v76, v24
  v_dot2c_f32_bf16 v21, v76, v76
  v_dot2c_f32_bf16 v22, v77, v24
  v_dot2c_f32_bf16 v23, v77, v77
  v_dot2c_f32_bf16 v20, v78, v24
  v_dot2c_f32_bf16 v21, v78, v78
  v_dot2c_f32_bf16 v22, v79, v24
  v_dot2c_f32_bf16 v23, v79, v79
  v_dot2c_f32_bf16 v20, v80, v24
  v_dot2c_f32_bf16 v21, v80, v80
  v_dot2c_f32_bf16 v22, v81, v24
  v_dot2c_f32_bf16 v23, v81, v81
  v_dot2c_f32_bf16 v20, v82, v24
  v_dot2c_f32_bf16 v21, v82, v82
  v_dot2c_f32_bf16 v22, v83, v24
  v_dot2c_f32_bf16 v23, v83, v83
  v_dot2c_f32_bf16 v20, v84, v24
  v_dot2c_f32_bf16 v21, v84, v84
  v_dot2c_f32_bf16 v22, v85, v24
  v_dot2c_f32_bf16 v23, v85, v85
  v_dot2c_f32_bf16 v20, v86, v24
  v_dot2c_f32_bf16 v21, v86, v86
  v_dot2c_f32_bf16 v22, v87, v24
  v_dot2c_f32_bf16 v23, v87, v87
  v_dot2c_f32_bf16 v20, v88, v24
  v_dot2c_f32_bf16 v21, v88, v88
  v_dot2c_f32_bf16 v22, v89, v24
  v_dot2c_f32_bf16 v23, v89, v89
  v_dot2c_f32_bf16 v20, v90, v24
  v_dot2c_f32_bf16 v21, v90, v90
  v_dot2c_f32_bf16 v22, v91, v24
  v_dot2c_f32_bf16 v23, v91, v91
  s_nop 1
  v_add_f32 v20, v20, v22
  v_add_f32 v21, v21, v23
  s_nop 0
  v_add_f32_dpp v20, v20, v20 quad_perm:[1,0,3,2] row_mask:0xf bank_mask:0xf
  v_add_f32_dpp v21, v21, v21 quad_perm:[1,0,3,2] row_mask:0xf bank_mask:0xf
  s_nop 0
  v_add_f32_dpp v20, v20, v20 quad_perm:[2,3,0,1] row_mask:0xf bank_mask:0xf
  v_add_f32_dpp v21, v21, v21 quad_perm:[2,3,0,1] row_mask:0xf bank_mask:0xf
  s_nop 0
  v_add_f32_dpp v20, v20, v20 row_half_mirror row_mask:0xf bank_mask:0xf
  v_add_f32_dpp v21, v21, v21 row_half_mirror row_mask:0xf bank_mask:0xf
  s_mov_b32 s13, 0x3b124925
  v_mul_f32 v20, s13, v20
  v_mul_f32 v21, s13, v21
  v_fma_f32 v21, -v20, v20, v21
  v_max_f32 v21, 0, v21
  v_cvt_pk_bf16_f32 v22, v20, v21
  v_lshlrev_b32 v20, 16, v22
  v_and_b32 v21, s46, v22
  v_add_f32 v21, 0x3727c5ac, v21
  v_cvt_pk_bf16_f32 v21, v21, v21
  v_and_b32 v21, s46, v21
  v_sqrt_f32 v21, v21
  s_nop 0
  v_cvt_pk_bf16_f32 v21, v21, v21
  v_and_b32 v21, s46, v21
  v_rcp_f32 v21, v21
  v_and_b32 v22, 0x38, v1
  ds_write_b64 v22, v[20:21] offset:64
L_nostat:
  v_lshrrev_b32 v24, 1, v3
  v_lshlrev_b32 v24, 10, v24
  v_and_b32 v25, 1, v3
  v_lshl_add_u32 v24, v25, 7, v24
  v_lshl_add_u32 v24, v4, 3, v24
  s_lshl_b32 s13, s8, 8
  s_add_u32 s13, s13, 32768
  v_add_u32 v24, s13, v24
  v_add_u32 v25, 57344, v24
  v_and_b32 v21, 7, v1
  v_mul_u32_u24 v20, 912, v21
  v_lshl_add_u32 v20, v3, 3, v20
  v_add_u32 v20, 12288, v20
  v_lshlrev_b32 v21, 3, v21
  s_waitcnt vmcnt(0) lgkmcnt(0)
  s_add_u32 s45, s44, 1
  s_and_b32 s45, s45, 0xbfffbfff
  v_mov_b32 v16, 0
  v_mov_b32 v17, 1
  s_mov_b64 exec, 1
  ds_add_u32 v16, v17 offset:0
  s_mov_b64 exec, -1
  s_add_u32 s85, s85, 4
  v_mov_b32 v16, 0
L_spinH1:
  ds_read_b32 v17, v16 offset:0
  s_waitcnt lgkmcnt(0)
  v_readfirstlane_b32 s13, v17
  s_nop 0
  s_cmp_ge_u32 s13, s85
  s_cbranch_scc1 L_spunH1
  s_sub_u32 s84, s84, 1
  s_cbranch_scc1 L_fin
  s_branch L_spinH1
L_spunH1:
  ds_read_b64 v[22:23], v21 offset:64
  ds_read2_b64 v[64:67], v20 offset0:0 offset1:4
  ds_read_b64_tr_b16 v[120:121], v24 offset:0
  ds_read_b64_tr_b16 v[122:123], v24 offset:2048
  ds_read_b64_tr_b16 v[176:177], v25 offset:0
  ds_read_b64_tr_b16 v[178:179], v25 offset:2048
  ds_read2_b64 v[68:71], v20 offset0:8 offset1:12
  ds_read_b64_tr_b16 v[124:125], v24 offset:4096
  ds_read_b64_tr_b16 v[126:127], v24 offset:6144
  ds_read_b64_tr_b16 v[180:181], v25 offset:4096
  ds_read_b64_tr_b16 v[182:183], v25 offset:6144
  ds_read2_b64 v[72:75], v20 offset0:16 offset1:20
  ds_read_b64_tr_b16 v[128:129], v24 offset:8192
  ds_read_b64_tr_b16 v[130:131], v24 offset:10240
  ds_read_b64_tr_b16 v[184:185], v25 offset:8192
  ds_read_b64_tr_b16 v[186:187], v25 offset:10240
  ds_read2_b64 v[76:79], v20 offset0:24 offset1:28
  ds_read_b64_tr_b16 v[132:133], v24 offset:12288
  ds_read_b64_tr_b16 v[134:135], v24 offset:14336
  ds_read_b64_tr_b16 v[188:189], v25 offset:12288
  ds_read_b64_tr_b16 v[190:191], v25 offset:14336
  ds_read2_b64 v[80:83], v20 offset0:32 offset1:36
  ds_read_b64_tr_b16 v[136:137], v24 offset:16384
  ds_read_b64_tr_b16 v[138:139], v24 offset:18432
  ds_read_b64_tr_b16 v[192:193], v25 offset:16384
  ds_read_b64_tr_b16 v[194:195], v25 offset:18432
  ds_read2_b64 v[84:87], v20 offset0:40 offset1:44
  ds_read_b64_tr_b16 v[140:141], v24 offset:20480
  ds_read_b64_tr_b16 v[142:143], v24 offset:22528
  ds_read_b64_tr_b16 v[196:197], v25 offset:20480
  ds_read_b64_tr_b16 v[198:199], v25 offset:22528
  ds_read2_b64 v[88:91], v20 offset0:48 offset1:52
  ds_read_b64_tr_b16 v[144:145], v24 offset:24576
  ds_read_b64_tr_b16 v[146:147], v24 offset:26624
  ds_read_b64_tr_b16 v[200:201], v25 offset:24576
  ds_read_b64_tr_b16 v[202:203], v25 offset:26624
  ds_read2_b64 v[92:95], v20 offset0:56 offset1:60
  ds_read_b64_tr_b16 v[148:149], v24 offset:28672
  ds_read_b64_tr_b16 v[150:151], v24 offset:30720
  ds_read_b64_tr_b16 v[204:205], v25 offset:28672
  ds_read_b64_tr_b16 v[206:207], v25 offset:30720
  ds_read2_b64 v[96:99], v20 offset0:64 offset1:68
  ds_read_b64_tr_b16 v[152:153], v24 offset:32768
  ds_read_b64_tr_b16 v[154:155], v24 offset:34816
  ds_read_b64_tr_b16 v[208:209], v25 offset:32768
  ds_read_b64_tr_b16 v[210:211], v25 offset:34816
  ds_read2_b64 v[100:103], v20 offset0:72 offset1:76
  ds_read_b64_tr_b16 v[156:157], v24 offset:36864
  ds_read_b64_tr_b16 v[158:159], v24 offset:38912
  ds_read_b64_tr_b16 v[212:213], v25 offset:36864
  ds_read_b64_tr_b16 v[214:215], v25 offset:38912
  ds_read2_b64 v[104:107], v20 offset0:80 offset1:84
  ds_read_b64_tr_b16 v[160:161], v24 offset:40960
  ds_read_b64_tr_b16 v[162:163], v24 offset:43008
  ds_read_b64_tr_b16 v[216:217], v25 offset:40960
  ds_read_b64_tr_b16 v[218:219], v25 offset:43008
  ds_read2_b64 v[108:111], v20 offset0:88 offset1:92
  ds_read_b64_tr_b16 v[164:165], v24 offset:45056
  ds_read_b64_tr_b16 v[166:167], v24 offset:47104
  ds_read_b64_tr_b16 v[220:221], v25 offset:45056
  ds_read_b64_tr_b16 v[222:223], v25 offset:47104
  ds_read2_b64 v[112:115], v20 offset0:96 offset1:100
  ds_read_b64_tr_b16 v[168:169], v24 offset:49152
  ds_read_b64_tr_b16 v[170:171], v24 offset:51200
  ds_read_b64_tr_b16 v[224:225], v25 offset:49152
  ds_read_b64_tr_b16 v[226:227], v25 offset:51200
  ds_read2_b64 v[116:119], v20 offset0:104 offset1:108
  ds_read_b64_tr_b16 v[172:173], v24 offset:53248
  ds_read_b64_tr_b16 v[174:175], v24 offset:55296
  ds_read_b64_tr_b16 v[228:229], v25 offset:53248
  ds_read_b64_tr_b16 v[230:231], v25 offset:55296
  s_waitcnt lgkmcnt(0)
  v_mov_b32 v16, 0
  v_mov_b32 v17, 1
  s_mov_b64 exec, 1
  ds_add_u32 v16, v17 offset:16
  s_mov_b64 exec, -1
  v_mfma_f32_16x16x32_bf16 v[24:27], v[120:123], v[64:67], 0
  v_mfma_f32_16x16x32_bf16 v[32:35], v[176:179], v[64:67], 0
  v_mfma_f32_16x16x32_bf16 v[24:27], v[124:127], v[68:71], v[24:27]
  v_mfma_f32_16x16x32_bf16 v[32:35], v[180:183], v[68:71], v[32:35]
  v_mfma_f32_16x16x32_bf16 v[24:27], v[128:131], v[72:75], v[24:27]
  v_mfma_f32_16x16x32_bf16 v[32:35], v[184:187], v[72:75], v[32:35]
  v_mfma_f32_16x16x32_bf16 v[24:27], v[132:135], v[76:79], v[24:27]
  v_mfma_f32_16x16x32_bf16 v[32:35], v[188:191], v[76:79], v[32:35]
  v_mfma_f32_16x16x32_bf16 v[24:27], v[136:139], v[80:83], v[24:27]
  v_mfma_f32_16x16x32_bf16 v[32:35], v[192:195], v[80:83], v[32:35]
  v_mfma_f32_16x16x32_bf16 v[24:27], v[140:143], v[84:87], v[24:27]
  v_mfma_f32_16x16x32_bf16 v[32:35], v[196:199], v[84:87], v[32:35]
  v_mfma_f32_16x16x32_bf16 v[24:27], v[144:147], v[88:91], v[24:27]
  v_mfma_f32_16x16x32_bf16 v[32:35], v[200:203], v[88:91], v[32:35]
  v_mfma_f32_16x16x32_bf16 v[24:27], v[148:151], v[92:95], v[24:27]
  v_mfma_f32_16x16x32_bf16 v[32:35], v[204:207], v[92:95], v[32:35]
  v_mfma_f32_16x16x32_bf16 v[24:27], v[152:155], v[96:99], v[24:27]
  v_mfma_f32_16x16x32_bf16 v[32:35], v[208:211], v[96:99], v[32:35]
  v_mfma_f32_16x16x32_bf16 v[24:27], v[156:159], v[100:103], v[24:27]
  v_mfma_f32_16x16x32_bf16 v[32:35], v[212:215], v[100:103], v[32:35]
  v_mfma_f32_16x16x32_bf16 v[24:27], v[160:163], v[104:107], v[24:27]
  v_mfma_f32_16x16x32_bf16 v[32:35], v[216:219], v[104:107], v[32:35]
  v_mfma_f32_16x16x32_bf16 v[24:27], v[164:167], v[108:111], v[24:27]
  v_mfma_f32_16x16x32_bf16 v[32:35], v[220:223], v[108:111], v[32:35]
  v_mfma_f32_16x16x32_bf16 v[24:27], v[168:171], v[112:115], v[24:27]
  v_mfma_f32_16x16x32_bf16 v[32:35], v[224:227], v[112:115], v[32:35]
  v_mfma_f32_16x16x32_bf16 v[24:27], v[172:175], v[116:119], v[24:27]
  v_mfma_f32_16x16x32_bf16 v[32:35], v[228:231], v[116:119], v[32:35]
  v_mov_b32 v29, s45
  v_mov_b32 v31, s45
  v_mov_b32 v37, s45
  v_mov_b32 v39, s45
  s_cmp_eq_u32 s9, 1
  s_cbranch_scc1 L_hepi
  v_lshlrev_b32 v16, 13, v4
  v_lshl_add_u32 v16, v3, 4, v16
  s_lshl_b32 s13, s11, 1
  s_lshl_b32 s14, s8, 6
  s_add_u32 s13, s13, s14
  s_add_u32 s13, s13, 65536
  v_cvt_pk_bf16_f32 v28, v24, v25
  v_cvt_pk_bf16_f32 v30, v26, v27
  v_cvt_pk_bf16_f32 v36, v32, v33
  v_cvt_pk_bf16_f32 v38, v34, v35
  s_mov_b32 exec_lo, 0x00ff00ff
  s_mov_b32 exec_hi, 0x00ff00ff
  buffer_store_dwordx4 v[28:31], v16, s[48:51], s13 offen sc1
  s_cmp_eq_u32 s9, 3
  s_cbranch_scc1 L_p1done
  buffer_store_dwordx4 v[36:39], v16, s[48:51], s13 offen offset:256 sc1
  s_branch L_p1done
L_hepi:
  v_lshlrev_b32 v40, 16, v18
  v_and_b32 v41, s46, v18
  v_lshlrev_b32 v42, 16, v19
  v_and_b32 v43, s46, v19
  v_sub_f32 v40, v40, v22
  v_sub_f32 v41, v41, v22
  v_sub_f32 v42, v42, v22
  v_sub_f32 v43, v43, v22
  v_cvt_pk_bf16_f32 v46, v40, v41
  v_lshlrev_b32 v40, 16, v46
  v_and_b32 v41, s46, v46
  v_cvt_pk_bf16_f32 v47, v42, v43
  v_lshlrev_b32 v42, 16, v47
  v_and_b32 v43, s46, v47
  v_mul_f32 v40, v40, v23
  v_mul_f32 v41, v41, v23
  v_mul_f32 v42, v42, v23
  v_mul_f32 v43, v43, v23
  v_cvt_pk_bf16_f32 v46, v40, v41
  v_lshlrev_b32 v40, 16, v46
  v_and_b32 v41, s46, v46
  v_cvt_pk_bf16_f32 v47, v42, v43
  v_lshlrev_b32 v42, 16, v47
  v_and_b32 v43, s46, v47
  v_cvt_pk_bf16_f32 v46, v32, v33
  v_lshlrev_b32 v32, 16, v46
  v_and_b32 v33, s46, v46
  v_cvt_pk_bf16_f32 v47, v34, v35
  v_lshlrev_b32 v34, 16, v47
  v_and_b32 v35, s46, v47
  v_cvt_pk_bf16_f32 v48, v24, v25
  v_lshlrev_b32 v24, 16, v48
  v_and_b32 v25, s46, v48
  v_cvt_pk_bf16_f32 v49, v26, v27
  v_lshlrev_b32 v26, 16, v49
  v_and_b32 v27, s46, v49
  v_add_f32 v32, 1.0, v32
  v_add_f32 v33, 1.0, v33
  v_add_f32 v34, 1.0, v34
  v_add_f32 v35, 1.0, v35
  v_cvt_pk_bf16_f32 v46, v32, v33
  v_lshlrev_b32 v32, 16, v46
  v_and_b32 v33, s46, v46
  v_cvt_pk_bf16_f32 v47, v34, v35
  v_lshlrev_b32 v34, 16, v47
  v_and_b32 v35, s46, v47
  v_mul_f32 v40, v40, v32
  v_mul_f32 v41, v41, v33
  v_mul_f32 v42, v42, v34
  v_mul_f32 v43, v43, v35
  v_cvt_pk_bf16_f32 v46, v40, v41
  v_lshlrev_b32 v40, 16, v46
  v_and_b32 v41, s46, v46
  v_cvt_pk_bf16_f32 v47, v42, v43
  v_lshlrev_b32 v42, 16, v47
  v_and_b32 v43, s46, v47
  v_add_f32 v40, v40, v24
  v_add_f32 v41, v41, v25
  v_add_f32 v42, v42, v26
  v_add_f32 v43, v43, v27
  v_cvt_pk_bf16_f32 v28, v40, v41
  v_cvt_pk_bf16_f32 v30, v42, v43
  v_lshlrev_b32 v16, 6, v4
  v_lshl_add_u32 v16, v3, 4, v16
  s_lshl_b32 s13, s10, 2
  s_add_u32 s13, s13, s8
  s_lshl_b32 s13, s13, 9
  s_add_u32 s13, s13, 4096
  s_mov_b32 exec_lo, 0x00ff00ff
  s_mov_b32 exec_hi, 0x00ff00ff
  buffer_store_dwordx4 v[28:31], v16, s[48:51], s13 offen sc1
L_p1done:
  s_mov_b64 exec, -1
  s_setprio 0
  s_branch L_wts
L_p2:
  s_add_u32 s11, s7, 1
  s_and_b32 s11, s11, 7
  s_lshl_b32 s13, s11, 10
  s_lshl_b32 s14, s4, 7
  s_add_u32 s13, s13, s14
  s_mul_i32 s14, s8, 917504
  s_add_u32 s13, s13, s14
  s_add_u32 s14, s13, 128
  s_mul_i32 s15, s8, 14336
  s_add_u32 m0, s15, 32768
  s_nop 0
  buffer_load_dwordx4 v7, s[56:59], s13 offen nt lds
  s_add_u32 s13, s13, 65536
  s_add_u32 m0, s15, 33792
  s_nop 0
  buffer_load_dwordx4 v7, s[56:59], s13 offen nt lds
  s_add_u32 s13, s13, 65536
  s_add_u32 m0, s15, 34816
  s_nop 0
  buffer_load_dwordx4 v7, s[56:59], s13 offen nt lds
  s_add_u32 s13, s13, 65536
  s_add_u32 m0, s15, 35840
  s_nop 0
  buffer_load_dwordx4 v7, s[56:59], s13 offen nt lds
  s_add_u32 s13, s13, 65536
  s_add_u32 m0, s15, 36864
  s_nop 0
  buffer_load_dwordx4 v7, s[56:59], s13 offen nt lds
  s_add_u32 s13, s13, 65536
  s_add_u32 m0, s15, 37888
  s_nop 0
  buffer_load_dwordx4 v7, s[56:59], s13 offen nt lds
  s_add_u32 s13, s13, 65536
  s_add_u32 m0, s15, 38912
  s_nop 0
  buffer_load_dwordx4 v7, s[56:59], s13 offen nt lds
  s_add_u32 s13, s13, 65536
  s_add_u32 m0, s15, 39936
  s_nop 0
  buffer_load_dwordx4 v7, s[56:59], s13 offen nt lds
  s_add_u32 s13, s13, 65536
  s_add_u32 m0, s15, 40960
  s_nop 0
  buffer_load_dwordx4 v7, s[56:59], s13 offen nt lds
  s_add_u32 s13, s13, 65536
  s_add_u32 m0, s15, 41984
  s_nop 0
  buffer_load_dwordx4 v7, s[56:59], s13 offen nt lds
  s_add_u32 s13, s13, 65536
  s_add_u32 m0, s15, 43008
  s_nop 0
  buffer_load_dwordx4 v7, s[56:59], s13 offen nt lds
  s_add_u32 s13, s13, 65536
  s_add_u32 m0, s15, 44032
  s_nop 0
  buffer_load_dwordx4 v7, s[56:59], s13 offen nt lds
  s_add_u32 s13, s13, 65536
  s_add_u32 m0, s15, 45056
  s_nop 0
  buffer_load_dwordx4 v7, s[56:59], s13 offen nt lds
  s_add_u32 s13, s13, 65536
  s_add_u32 m0, s15, 46080
  s_nop 0
  buffer_load_dwordx4 v7, s[56:59], s13 offen nt lds
  s_add_u32 m0, s15, 90112
  s_nop 0
  buffer_load_dwordx4 v7, s[56:59], s14 offen nt lds
  s_add_u32 s14, s14, 65536
  s_add_u32 m0, s15, 91136
  s_nop 0
  buffer_load_dwordx4 v7, s[56:59], s14 offen nt lds
  s_add_u32 s14, s14, 65536
  s_add_u32 m0, s15, 92160
  s_nop 0
  buffer_load_dwordx4 v7, s[56:59], s14 offen nt lds
  s_add_u32 s14, s14, 65536
  s_add_u32 m0, s15, 93184
  s_nop 0
  buffer_load_dwordx4 v7, s[56:59], s14 offen nt lds
  s_add_u32 s14, s14, 65536
  s_add_u32 m0, s15, 94208
  s_nop 0
  buffer_load_dwordx4 v7, s[56:59], s14 offen nt lds
  s_add_u32 s14, s14, 65536
  s_add_u32 m0, s15, 95232
  s_nop 0
  buffer_load_dwordx4 v7, s[56:59], s14 offen nt lds
  s_add_u32 s14, s14, 65536
  s_add_u32 m0, s15, 96256
  s_nop 0
  buffer_load_dwordx4 v7, s[56:59], s14 offen nt lds
  s_add_u32 s14, s14, 65536
  s_add_u32 m0, s15, 97280
  s_nop 0
  buffer_load_dwordx4 v7, s[56:59], s14 offen nt lds
  s_add_u32 s14, s14, 65536
  s_add_u32 m0, s15, 98304
  s_nop 0
  buffer_load_dwordx4 v7, s[56:59], s14 offen nt lds
  s_add_u32 s14, s14, 65536
  s_add_u32 m0, s15, 99328
  s_nop 0
  buffer_load_dwordx4 v7, s[56:59], s14 offen nt lds
  s_add_u32 s14, s14, 65536
  s_add_u32 m0, s15, 100352
  s_nop 0
  buffer_load_dwordx4 v7, s[56:59], s14 offen nt lds
  s_add_u32 s14, s14, 65536
  s_add_u32 m0, s15, 101376
  s_nop 0
  buffer_load_dwordx4 v7, s[56:59], s14 offen nt lds
  s_add_u32 s14, s14, 65536
  s_add_u32 m0, s15, 102400
  s_nop 0
  buffer_load_dwordx4 v7, s[56:59], s14 offen nt lds
  s_add_u32 s14, s14, 65536
  s_add_u32 m0, s15, 103424
  s_nop 0
  buffer_load_dwordx4 v7, s[56:59], s14 offen nt lds
  v_lshrrev_b32 v24, 1, v3
  v_lshlrev_b32 v24, 10, v24
  v_and_b32 v25, 1, v3
  v_lshl_add_u32 v24, v25, 7, v24
  v_lshl_add_u32 v24, v4, 3, v24
  s_lshl_b32 s13, s8, 8
  s_add_u32 s13, s13, 32768
  v_add_u32 v24, s13, v24
  v_add_u32 v25, 57344, v24
  v_and_b32 v21, 7, v1
  v_mul_u32_u24 v20, 912, v21
  v_lshl_add_u32 v20, v3, 3, v20
  v_add_u32 v20, 12288, v20
  v_lshlrev_b32 v18, 6, v21
  v_lshl_add_u32 v18, v3, 4, v18
  v_bfe_u32 v21, v1, 3, 1
  v_lshl_add_u32 v19, v21, 9, v18
  s_mul_i32 s13, s8, 224
  v_add_u32 v54, s13, v20
  v_lshl_add_u32 v55, v21, 5, v54
  s_lshl_b32 s15, s11, 5
  s_lshl_b32 s13, s4, 2
  s_add_u32 s15, s15, s13
  s_add_u32 s15, s15, s8
  s_lshl_b32 s15, s15, 9
  s_add_u32 s15, s15, 262144
  s_mul_i32 s11, s8, 3584
  s_add_u32 s11, s11, 4096
  s_waitcnt vmcnt(0) lgkmcnt(0)
  s_add_u32 s45, s44, 1
  s_and_b32 s45, s45, 0xbfffbfff
  v_mov_b32 v16, 0
  v_mov_b32 v17, 1
  s_mov_b64 exec, 1
  ds_add_u32 v16, v17 offset:0
  s_mov_b64 exec, -1
  s_add_u32 s85, s85, 4
  v_mov_b32 v16, 0
L_spinH2:
  ds_read_b32 v17, v16 offset:0
  s_waitcnt lgkmcnt(0)
  v_readfirstlane_b32 s13, v17
  s_nop 0
  s_cmp_ge_u32 s13, s85
  s_cbranch_scc1 L_spunH2
  s_sub_u32 s84, s84, 1
  s_cbranch_scc1 L_fin
  s_branch L_spinH2
L_spunH2:
  ds_read_b64_tr_b16 v[120:121], v24 offset:0
  ds_read_b64_tr_b16 v[122:123], v24 offset:2048
  ds_read_b64_tr_b16 v[176:177], v25 offset:0
  ds_read_b64_tr_b16 v[178:179], v25 offset:2048
  ds_read_b64_tr_b16 v[124:125], v24 offset:4096
  ds_read_b64_tr_b16 v[126:127], v24 offset:6144
  ds_read_b64_tr_b16 v[180:181], v25 offset:4096
  ds_read_b64_tr_b16 v[182:183], v25 offset:6144
  ds_read_b64_tr_b16 v[128:129], v24 offset:8192
  ds_read_b64_tr_b16 v[130:131], v24 offset:10240
  ds_read_b64_tr_b16 v[184:185], v25 offset:8192
  ds_read_b64_tr_b16 v[186:187], v25 offset:10240
  ds_read_b64_tr_b16 v[132:133], v24 offset:12288
  ds_read_b64_tr_b16 v[134:135], v24 offset:14336
  ds_read_b64_tr_b16 v[188:189], v25 offset:12288
  ds_read_b64_tr_b16 v[190:191], v25 offset:14336
  ds_read_b64_tr_b16 v[136:137], v24 offset:16384
  ds_read_b64_tr_b16 v[138:139], v24 offset:18432
  ds_read_b64_tr_b16 v[192:193], v25 offset:16384
  ds_read_b64_tr_b16 v[194:195], v25 offset:18432
  ds_read_b64_tr_b16 v[140:141], v24 offset:20480
  ds_read_b64_tr_b16 v[142:143], v24 offset:22528
  ds_read_b64_tr_b16 v[196:197], v25 offset:20480
  ds_read_b64_tr_b16 v[198:199], v25 offset:22528
  ds_read_b64_tr_b16 v[144:145], v24 offset:24576
  ds_read_b64_tr_b16 v[146:147], v24 offset:26624
  ds_read_b64_tr_b16 v[200:201], v25 offset:24576
  ds_read_b64_tr_b16 v[202:203], v25 offset:26624
  ds_read_b64_tr_b16 v[148:149], v24 offset:28672
  ds_read_b64_tr_b16 v[150:151], v24 offset:30720
  ds_read_b64_tr_b16 v[204:205], v25 offset:28672
  ds_read_b64_tr_b16 v[206:207], v25 offset:30720
  ds_read_b64_tr_b16 v[152:153], v24 offset:32768
  ds_read_b64_tr_b16 v[154:155], v24 offset:34816
  ds_read_b64_tr_b16 v[208:209], v25 offset:32768
  ds_read_b64_tr_b16 v[210:211], v25 offset:34816
  ds_read_b64_tr_b16 v[156:157], v24 offset:36864
  ds_read_b64_tr_b16 v[158:159], v24 offset:38912
  ds_read_b64_tr_b16 v[212:213], v25 offset:36864
  ds_read_b64_tr_b16 v[214:215], v25 offset:38912
  ds_read_b64_tr_b16 v[160:161], v24 offset:40960
  ds_read_b64_tr_b16 v[162:163], v24 offset:43008
  ds_read_b64_tr_b16 v[216:217], v25 offset:40960
  ds_read_b64_tr_b16 v[218:219], v25 offset:43008
  ds_read_b64_tr_b16 v[164:165], v24 offset:45056
  ds_read_b64_tr_b16 v[166:167], v24 offset:47104
  ds_read_b64_tr_b16 v[220:221], v25 offset:45056
  ds_read_b64_tr_b16 v[222:223], v25 offset:47104
  ds_read_b64_tr_b16 v[168:169], v24 offset:49152
  ds_read_b64_tr_b16 v[170:171], v24 offset:51200
  ds_read_b64_tr_b16 v[224:225], v25 offset:49152
  ds_read_b64_tr_b16 v[226:227], v25 offset:51200
  ds_read_b64_tr_b16 v[172:173], v24 offset:53248
  ds_read_b64_tr_b16 v[174:175], v24 offset:55296
  ds_read_b64_tr_b16 v[228:229], v25 offset:53248
  ds_read_b64_tr_b16 v[230:231], v25 offset:55296
  s_waitcnt lgkmcnt(0)
  v_mov_b32 v16, 0
  v_mov_b32 v17, 1
  s_mov_b64 exec, 1
  ds_add_u32 v16, v17 offset:16
  s_mov_b64 exec, -1
L_pollH:
  buffer_load_dwordx4 v[24:27], v19, s[48:51], s11 offen offset:0 sc1
  buffer_load_dwordx4 v[28:31], v19, s[48:51], s11 offen offset:1024 sc1
  buffer_load_dwordx4 v[32:35], v19, s[48:51], s11 offen offset:2048 sc1
  buffer_load_dwordx4 v[36:39], v18, s[48:51], s11 offen offset:3072 sc1
  s_waitcnt vmcnt(0)
  v_xor_b32 v22, s45, v25
  v_xor_b32 v23, s45, v27
  v_bitop3_b32 v22, v22, v29, s45 bitop3:0xf6
  v_bitop3_b32 v23, v23, v31, s45 bitop3:0xf6
  v_bitop3_b32 v22, v22, v33, s45 bitop3:0xf6
  v_bitop3_b32 v23, v23, v35, s45 bitop3:0xf6
  v_bitop3_b32 v22, v22, v37, s45 bitop3:0xf6
  v_bitop3_b32 v23, v23, v39, s45 bitop3:0xf6
  v_or_b32 v22, v22, v23
  v_cmp_ne_u32 vcc, 0, v22
  s_nop 0
  s_mov_b64 exec, vcc
  s_cbranch_execz L_gotH
  s_sub_u32 s84, s84, 1
  s_cbranch_scc1 L_fin
  s_branch L_pollH
L_gotH:
  s_mov_b64 exec, -1
  v_mov_b32 v25, v26
  v_mov_b32 v29, v30
  v_mov_b32 v33, v34
  v_mov_b32 v37, v38
  ds_write_b64 v55, v[24:25] offset:0
  ds_write_b64 v55, v[28:29] offset:64
  ds_write_b64 v55, v[32:33] offset:128
  ds_write_b64 v54, v[36:37] offset:192
  s_waitcnt lgkmcnt(0)
  v_mov_b32 v16, 0
  v_mov_b32 v17, 1
  s_mov_b64 exec, 1
  ds_add_u32 v16, v17 offset:0
  s_mov_b64 exec, -1
  s_add_u32 s85, s85, 4
  v_mov_b32 v16, 0
L_spinH3:
  ds_read_b32 v17, v16 offset:0
  s_waitcnt lgkmcnt(0)
  v_readfirstlane_b32 s13, v17
  s_nop 0
  s_cmp_ge_u32 s13, s85
  s_cbranch_scc1 L_spunH3
  s_sub_u32 s84, s84, 1
  s_cbranch_scc1 L_fin
  s_branch L_spinH3
L_spunH3:
  ds_read2_b64 v[64:67], v20 offset0:0 offset1:4
  ds_read2_b64 v[68:71], v20 offset0:8 offset1:12
  ds_read2_b64 v[72:75], v20 offset0:16 offset1:20
  ds_read2_b64 v[76:79], v20 offset0:24 offset1:28
  ds_read2_b64 v[80:83], v20 offset0:32 offset1:36
  ds_read2_b64 v[84:87], v20 offset0:40 offset1:44
  ds_read2_b64 v[88:91], v20 offset0:48 offset1:52
  ds_read2_b64 v[92:95], v20 offset0:56 offset1:60
  ds_read2_b64 v[96:99], v20 offset0:64 offset1:68
  ds_read2_b64 v[100:103], v20 offset0:72 offset1:76
  ds_read2_b64 v[104:107], v20 offset0:80 offset1:84
  ds_read2_b64 v[108:111], v20 offset0:88 offset1:92
  ds_read2_b64 v[112:115], v20 offset0:96 offset1:100
  ds_read2_b64 v[116:119], v20 offset0:104 offset1:108
  s_waitcnt lgkmcnt(0)
  v_mfma_f32_16x16x32_bf16 v[24:27], v[120:123], v[64:67], 0
  v_mfma_f32_16x16x32_bf16 v[32:35], v[176:179], v[64:67], 0
  v_mfma_f32_16x16x32_bf16 v[24:27], v[124:127], v[68:71], v[24:27]
  v_mfma_f32_16x16x32_bf16 v[32:35], v[180:183], v[68:71], v[32:35]
  v_mfma_f32_16x16x32_bf16 v[24:27], v[128:131], v[72:75], v[24:27]
  v_mfma_f32_16x16x32_bf16 v[32:35], v[184:187], v[72:75], v[32:35]
  v_mfma_f32_16x16x32_bf16 v[24:27], v[132:135], v[76:79], v[24:27]
  v_mfma_f32_16x16x32_bf16 v[32:35], v[188:191], v[76:79], v[32:35]
  v_mfma_f32_16x16x32_bf16 v[24:27], v[136:139], v[80:83], v[24:27]
  v_mfma_f32_16x16x32_bf16 v[32:35], v[192:195], v[80:83], v[32:35]
  v_mfma_f32_16x16x32_bf16 v[24:27], v[140:143], v[84:87], v[24:27]
  v_mfma_f32_16x16x32_bf16 v[32:35], v[196:199], v[84:87], v[32:35]
  v_mfma_f32_16x16x32_bf16 v[24:27], v[144:147], v[88:91], v[24:27]
  v_mfma_f32_16x16x32_bf16 v[32:35], v[200:203], v[88:91], v[32:35]
  v_mfma_f32_16x16x32_bf16 v[24:27], v[148:151], v[92:95], v[24:27]
  v_mfma_f32_16x16x32_bf16 v[32:35], v[204:207], v[92:95], v[32:35]
  v_mfma_f32_16x16x32_bf16 v[24:27], v[152:155], v[96:99], v[24:27]
  v_mfma_f32_16x16x32_bf16 v[32:35], v[208:211], v[96:99], v[32:35]
  v_mfma_f32_16x16x32_bf16 v[24:27], v[156:159], v[100:103], v[24:27]
  v_mfma_f32_16x16x32_bf16 v[32:35], v[212:215], v[100:103], v[32:35]
  v_mfma_f32_16x16x32_bf16 v[24:27], v[160:163], v[104:107], v[24:27]
  v_mfma_f32_16x16x32_bf16 v[32:35], v[216:219], v[104:107], v[32:35]
  v_mfma_f32_16x16x32_bf16 v[24:27], v[164:167], v[108:111], v[24:27]
  v_mfma_f32_16x16x32_bf16 v[32:35], v[220:223], v[108:111], v[32:35]
  v_mfma_f32_16x16x32_bf16 v[24:27], v[168:171], v[112:115], v[24:27]
  v_mfma_f32_16x16x32_bf16 v[32:35], v[224:227], v[112:115], v[32:35]
  v_mfma_f32_16x16x32_bf16 v[24:27], v[172:175], v[116:119], v[24:27]
  v_mfma_f32_16x16x32_bf16 v[32:35], v[228:231], v[116:119], v[32:35]
  v_mov_b32 v29, s45
  v_mov_b32 v31, s45
  v_mov_b32 v37, s45
  v_mov_b32 v39, s45
  s_nop 2
  v_cvt_pk_bf16_f32 v28, v24, v25
  v_cvt_pk_bf16_f32 v30, v26, v27
  v_cvt_pk_bf16_f32 v36, v32, v33
  v_cvt_pk_bf16_f32 v38, v34, v35
  s_mov_b32 exec_lo, 0x00ff00ff
  s_mov_b32 exec_hi, 0x00ff00ff
  buffer_store_dwordx4 v[28:31], v18, s[48:51], s15 offen sc1
  buffer_store_dwordx4 v[36:39], v18, s[48:51], s15 offen offset:2048 sc1
  s_mov_b64 exec, -1
  s_setprio 0
L_wts:
  v_lshrrev_b32 v4, 4, v1
  s_cmp_lt_u32 s47, 28
  s_cbranch_scc1 L_mwfh
  v_mul_u32_u24 v4, 14336, v4
  s_cmp_eq_u32 s5, 3
  s_cselect_b32 s13, 7, 15
  v_and_b32 v5, s13, v1
  v_lshl_add_u32 v4, v5, 4, v4
  s_lshl_b32 s13, s6, 3
  s_add_u32 s13, s13, s8
  s_mul_i32 s13, s13, 57344
  s_lshl_b32 s14, s5, 8
  s_add_u32 s13, s13, s14
  s_bitcmp0_b32 s4, 0
  s_cselect_b32 s72, 896, 0
  s_cselect_b32 s14, -1, 0
  v_and_b32 v4, s14, v4
  v_mov_b32 v6, s24
  v_mov_b32 v7, s25
  s_branch L_mwjh
L_mwfh:
  v_mul_u32_u24 v4, 3584, v4
  v_and_b32 v5, 7, v1
  v_lshl_add_u32 v4, v5, 4, v4
  s_mul_i32 s13, s8, 172032
  s_add_u32 s13, s13, 917504
  s_lshl_b32 s14, s47, 7
  s_add_u32 s13, s13, s14
  s_movk_i32 s72, 14336
  s_mov_b32 vcc_lo, 0xff00ff00
  s_mov_b32 vcc_hi, 0xff00ff00
  v_mov_b32 v5, s28
  v_mov_b32 v6, s30
  v_cndmask_b32 v6, v5, v6, vcc
  v_mov_b32 v5, s29
  v_mov_b32 v7, s31
  v_cndmask_b32 v7, v5, v7, vcc
L_mwjh:
  v_add_u32 v4, s13, v4
  v_add_co_u32 v56, vcc, v6, v4
  s_nop 1
  v_addc_co_u32 v57, vcc, 0, v7, vcc
  s_cmp_lt_u32 s47, 28
  s_cbranch_scc1 L_wf
  s_cmp_eq_u32 s8, 3
  s_cselect_b32 s13, s12, 0
  s_cmp_lg_u32 s13, 0
  s_cbranch_scc1 L_q
L_wt1:
  global_load_dwordx4 v[128:131], v[56:57], off
  v_add_co_u32 v56, s[14:15], s72, v56
  s_nop 1
  v_addc_co_u32 v57, s[14:15], 0, v57, s[14:15]
  global_load_dwordx4 v[132:135], v[56:57], off
  v_add_co_u32 v56, s[14:15], s72, v56
  s_nop 1
  v_addc_co_u32 v57, s[14:15], 0, v57, s[14:15]
  global_load_dwordx4 v[136:139], v[56:57], off
  v_add_co_u32 v56, s[14:15], s72, v56
  s_nop 1
  v_addc_co_u32 v57, s[14:15], 0, v57, s[14:15]
  global_load_dwordx4 v[140:143], v[56:57], off
  v_add_co_u32 v56, s[14:15], s72, v56
  s_nop 1
  v_addc_co_u32 v57, s[14:15], 0, v57, s[14:15]
  global_load_dwordx4 v[144:147], v[56:57], off
  v_add_co_u32 v56, s[14:15], s72, v56
  s_nop 1
  v_addc_co_u32 v57, s[14:15], 0, v57, s[14:15]
  global_load_dwordx4 v[148:151], v[56:57], off
  v_add_co_u32 v56, s[14:15], s72, v56
  s_nop 1
  v_addc_co_u32 v57, s[14:15], 0, v57, s[14:15]
  global_load_dwordx4 v[152:155], v[56:57], off
  v_add_co_u32 v56, s[14:15], s72, v56
  s_nop 1
  v_addc_co_u32 v57, s[14:15], 0, v57, s[14:15]
  global_load_dwordx4 v[156:159], v[56:57], off
  v_add_co_u32 v56, s[14:15], s72, v56
  s_nop 1
  v_addc_co_u32 v57, s[14:15], 0, v57, s[14:15]
  s_waitcnt vmcnt(7)
  global_load_dwordx4 v[160:163], v[56:57], off
  v_add_co_u32 v56, s[14:15], s72, v56
  s_nop 1
  v_addc_co_u32 v57, s[14:15], 0, v57, s[14:15]
  s_waitcnt vmcnt(7)
  global_load_dwordx4 v[164:167], v[56:57], off
  v_add_co_u32 v56, s[14:15], s72, v56
  s_nop 1
  v_addc_co_u32 v57, s[14:15], 0, v57, s[14:15]
  s_waitcnt vmcnt(7)
  global_load_dwordx4 v[168:171], v[56:57], off
  v_add_co_u32 v56, s[14:15], s72, v56
  s_nop 1
  v_addc_co_u32 v57, s[14:15], 0, v57, s[14:15]
  s_waitcnt vmcnt(7)
  global_load_dwordx4 v[172:175], v[56:57], off
  v_add_co_u32 v56, s[14:15], s72, v56
  s_nop 1
  v_addc_co_u32 v57, s[14:15], 0, v57, s[14:15]
  s_waitcnt vmcnt(7)
  global_load_dwordx4 v[176:179], v[56:57], off
  v_add_co_u32 v56, s[14:15], s72, v56
  s_nop 1
  v_addc_co_u32 v57, s[14:15], 0, v57, s[14:15]
  s_waitcnt vmcnt(7)
  global_load_dwordx4 v[180:183], v[56:57], off
  v_add_co_u32 v56, s[14:15], s72, v56
  s_nop 1
  v_addc_co_u32 v57, s[14:15], 0, v57, s[14:15]
  s_waitcnt vmcnt(7)
  global_load_dwordx4 v[184:187], v[56:57], off
  v_add_co_u32 v56, s[14:15], s72, v56
  s_nop 1
  v_addc_co_u32 v57, s[14:15], 0, v57, s[14:15]
  s_waitcnt vmcnt(7)
  global_load_dwordx4 v[188:191], v[56:57], off
  v_add_co_u32 v56, s[14:15], s72, v56
  s_nop 1
  v_addc_co_u32 v57, s[14:15], 0, v57, s[14:15]
  s_cmp_eq_u32 s8, 3
  s_cselect_b32 s13, s12, 1
  s_cmp_eq_u32 s13, 0
  s_cbranch_scc1 L_q
L_wt2:
  s_branch L_duty
L_wf:
  s_mov_b32 s64, s32
  s_mov_b32 s65, s33
  s_mov_b32 s66, 1605632
  s_mov_b32 s67, 0x20000
  s_cmp_eq_u32 s8, 3
  s_cselect_b32 s13, 7, 15
  v_and_b32 v5, s13, v1
  v_mul_u32_u24 v59, 1792, v3
  v_lshl_add_u32 v59, v5, 4, v59
  s_mul_i32 s11, s47, 57344
  s_lshl_b32 s13, s8, 8
  s_add_u32 s11, s11, s13
  global_load_dwordx4 v[128:131], v[56:57], off
  v_add_co_u32 v56, s[14:15], s72, v56
  s_nop 1
  v_addc_co_u32 v57, s[14:15], 0, v57, s[14:15]
  global_load_dwordx4 v[132:135], v[56:57], off
  v_add_co_u32 v56, s[14:15], s72, v56
  s_nop 1
  v_addc_co_u32 v57, s[14:15], 0, v57, s[14:15]
  global_load_dwordx4 v[136:139], v[56:57], off
  v_add_co_u32 v56, s[14:15], s72, v56
  s_nop 1
  v_addc_co_u32 v57, s[14:15], 0, v57, s[14:15]
  global_load_dwordx4 v[140:143], v[56:57], off
  v_add_co_u32 v56, s[14:15], s72, v56
  s_nop 1
  v_addc_co_u32 v57, s[14:15], 0, v57, s[14:15]
  global_load_dwordx4 v[144:147], v[56:57], off
  v_add_co_u32 v56, s[14:15], s72, v56
  s_nop 1
  v_addc_co_u32 v57, s[14:15], 0, v57, s[14:15]
  global_load_dwordx4 v[148:151], v[56:57], off
  v_add_co_u32 v56, s[14:15], s72, v56
  s_nop 1
  v_addc_co_u32 v57, s[14:15], 0, v57, s[14:15]
  global_load_dwordx4 v[152:155], v[56:57], off
  v_add_co_u32 v56, s[14:15], s72, v56
  s_nop 1
  v_addc_co_u32 v57, s[14:15], 0, v57, s[14:15]
  global_load_dwordx4 v[156:159], v[56:57], off
  v_add_co_u32 v56, s[14:15], s72, v56
  s_nop 1
  v_addc_co_u32 v57, s[14:15], 0, v57, s[14:15]
  s_waitcnt vmcnt(7)
  global_load_dwordx4 v[160:163], v[56:57], off
  v_add_co_u32 v56, s[14:15], s72, v56
  s_nop 1
  v_addc_co_u32 v57, s[14:15], 0, v57, s[14:15]
  s_waitcnt vmcnt(7)
  global_load_dwordx4 v[164:167], v[56:57], off
  v_add_co_u32 v56, s[14:15], s72, v56
  s_nop 1
  v_addc_co_u32 v57, s[14:15], 0, v57, s[14:15]
  s_waitcnt vmcnt(7)
  global_load_dwordx4 v[168:171], v[56:57], off
  v_add_co_u32 v56, s[14:15], s72, v56
  s_nop 1
  v_addc_co_u32 v57, s[14:15], 0, v57, s[14:15]
  s_waitcnt vmcnt(7)
  global_load_dwordx4 v[172:175], v[56:57], off
  v_add_co_u32 v56, s[14:15], s72, v56
  s_nop 1
  v_addc_co_u32 v57, s[14:15], 0, v57, s[14:15]
  s_waitcnt vmcnt(7)
  buffer_load_dwordx4 v[64:67], v59, s[64:67], s11 offen offset:0
  s_waitcnt vmcnt(7)
  buffer_load_dwordx4 v[68:71], v59, s[64:67], s11 offen offset:896
  s_add_u32 s11, s11, 7168
  s_waitcnt vmcnt(7)
  buffer_load_dwordx4 v[72:75], v59, s[64:67], s11 offen offset:0
  s_waitcnt vmcnt(7)
  buffer_load_dwordx4 v[76:79], v59, s[64:67], s11 offen offset:896
  s_add_u32 s11, s11, 7168
  s_waitcnt vmcnt(7)
  buffer_load_dwordx4 v[80:83], v59, s[64:67], s11 offen offset:0
  s_waitcnt vmcnt(7)
  buffer_load_dwordx4 v[84:87], v59, s[64:67], s11 offen offset:896
  s_add_u32 s11, s11, 7168
  s_waitcnt vmcnt(7)
  buffer_load_dwordx4 v[88:91], v59, s[64:67], s11 offen offset:0
  s_waitcnt vmcnt(7)
  buffer_load_dwordx4 v[92:95], v59, s[64:67], s11 offen offset:896
  s_add_u32 s11, s11, 7168
  s_waitcnt vmcnt(7)
  buffer_load_dwordx4 v[96:99], v59, s[64:67], s11 offen offset:0
  s_waitcnt vmcnt(7)
  buffer_load_dwordx4 v[100:103], v59, s[64:67], s11 offen offset:896
  s_add_u32 s11, s11, 7168
  s_waitcnt vmcnt(7)
  buffer_load_dwordx4 v[104:107], v59, s[64:67], s11 offen offset:0
  s_waitcnt vmcnt(7)
  buffer_load_dwordx4 v[108:111], v59, s[64:67], s11 offen offset:896
  s_add_u32 s11, s11, 7168
  s_cmp_eq_u32 s8, 3
  s_cbranch_scc1 L_q
L_wf2:
  s_waitcnt vmcnt(7)
  buffer_load_dwordx4 v[112:115], v59, s[64:67], s11 offen offset:0
  s_waitcnt vmcnt(7)
  buffer_load_dwordx4 v[116:119], v59, s[64:67], s11 offen offset:896
  s_add_u32 s11, s11, 7168
  s_waitcnt vmcnt(7)
  buffer_load_dwordx4 v[120:123], v59, s[64:67], s11 offen offset:0
  s_waitcnt vmcnt(7)
  buffer_load_dwordx4 v[124:127], v59, s[64:67], s11 offen offset:896
  s_branch L_duty
L_q:
  s_setprio 3
  v_bfe_u32 v52, v1, 3, 1
  v_lshlrev_b32 v52, 13, v52
  v_lshl_add_u32 v52, v3, 11, v52
  v_bfe_u32 v53, v1, 1, 2
  v_lshl_add_u32 v52, v53, 9, v52
  v_and_b32 v53, 1, v1
  v_lshl_add_u32 v52, v53, 5, v52
  s_lshl_b32 s68, s7, 14
  s_lshl_b32 s13, s4, 6
  s_add_u32 s68, s68, s13
  s_add_u32 s68, s68, 262144
  s_waitcnt lgkmcnt(0)
  s_add_u32 s45, s44, 1
  s_and_b32 s45, s45, 0xbfffbfff
  s_getreg_b32 s13, hwreg(HW_REG_XCC_ID, 0, 4)
  v_mov_b32 v16, s13
  v_mov_b32 v17, s45
  s_lshl_b32 s13, s2, 3
  s_add_u32 s13, s13, 2048
  v_mov_b32 v18, 0
  s_mov_b64 exec, 1
  buffer_store_dwordx2 v[16:17], v18, s[48:51], s13 offen sc1
  s_mov_b64 exec, -1
L_pollQ:
  buffer_load_dwordx4 v[32:35], v52, s[48:51], s68 offen sc1
  buffer_load_dwordx4 v[36:39], v52, s[48:51], s68 offen offset:16 sc1
  s_waitcnt vmcnt(0)
  v_xor_b32 v22, s45, v33
  v_xor_b32 v23, s45, v35
  v_bitop3_b32 v22, v22, v37, s45 bitop3:0xf6
  v_bitop3_b32 v23, v23, v39, s45 bitop3:0xf6
  v_or_b32 v22, v22, v23
  v_cmp_ne_u32 vcc, 0, v22
  s_nop 0
  s_mov_b64 exec, vcc
  s_cbranch_execz L_gotQ
  s_sub_u32 s84, s84, 1
  s_cbranch_scc1 L_fin
  s_branch L_pollQ
L_gotQ:
  s_mov_b64 exec, -1
  v_mov_b32 v33, v34
  v_mov_b32 v34, v36
  v_mov_b32 v35, v38
  v_mov_b32 v16, 0
  v_mov_b32 v22, 1
  v_mov_b32 v23, s45
  ds_write_b128 v2, v[32:35] offset:256
  ds_write_b64 v16, v[22:23] offset:8
  s_setprio 0
  s_cmp_lt_u32 s47, 28
  s_cbranch_scc1 L_wf2
  s_cmp_lg_u32 s12, 0
  s_cbranch_scc1 L_wt1
  s_branch L_wt2
L_duty:
  v_mov_b32 v4, 0
L_spinT:
  ds_read_b32 v5, v4 offset:8
  s_waitcnt lgkmcnt(0)
  v_readfirstlane_b32 s13, v5
  s_nop 0
  s_cmp_ge_u32 s13, 1
  s_cbranch_scc1 L_spunT
  s_sub_u32 s84, s84, 1
  s_cbranch_scc1 L_fin
  s_branch L_spinT
L_spunT:
  ds_read_b32 v5, v4 offset:12
  s_waitcnt lgkmcnt(0)
  v_readfirstlane_b32 s45, v5
  v_and_b32 v4, 1, v1
  v_lshlrev_b32 v4, 4, v4
  v_mov_b32 v5, 0xffff
  v_lshlrev_b32 v4, v4, v5
  v_bfe_u32 v5, v1, 1, 2
  v_cmp_eq_u32 vcc, 0, v5
  s_nop 1
  v_cndmask_b32 v16, 0, v4, vcc
  v_cmp_eq_u32 vcc, 1, v5
  s_nop 1
  v_cndmask_b32 v17, 0, v4, vcc
  v_cmp_eq_u32 vcc, 2, v5
  s_nop 1
  v_cndmask_b32 v18, 0, v4, vcc
  v_cmp_eq_u32 vcc, 3, v5
  s_nop 1
  v_cndmask_b32 v19, 0, v4, vcc
  v_lshrrev_b32 v4, 4, v1
  v_bfe_u32 v5, v1, 3, 1
  v_and_b32 v6, 7, v1
  s_cmp_lt_u32 s47, 28
  s_cbranch_scc1 L_tsfh
  v_lshlrev_b32 v192, 17, v5
  v_lshl_add_u32 v192, v4, 10, v192
  v_lshl_add_u32 v192, v6, 4, v192
  v_lshlrev_b32 v193, 12, v5
  v_lshl_add_u32 v193, v4, 7, v193
  s_lshl_b32 s13, s4, 3
  s_add_u32 s13, s13, s6
  s_lshl_b32 s76, s13, 14
  s_lshl_b32 s14, s8, 12
  s_add_u32 s76, s76, s14
  s_add_u32 s76, s76, 1048576
  s_lshl_b32 s77, s13, 9
  s_add_u32 s77, s77, 32768
  s_lshl_b32 s70, s4, 4
  s_lshl_b32 s14, s6, 2
  s_add_u32 s70, s70, s14
  s_add_u32 s70, s70, s5
  s_lshl_b32 s70, s70, 2
  s_add_u32 s70, s70, 1024
  v_lshrrev_b32 v194, 1, v4
  v_lshlrev_b32 v194, 9, v194
  v_and_b32 v7, 15, v1
  v_lshl_add_u32 v194, v7, 5, v194
  v_and_b32 v7, 1, v4
  v_lshl_add_u32 v194, v7, 4, v194
  s_lshl_b32 s14, s3, 10
  v_add_u32 v194, s14, v194
  s_lshl_b32 s14, s8, 9
  v_lshlrev_b32 v196, 3, v1
  s_add_u32 s14, s14, 4096
  v_add_u32 v195, s14, v196
  s_lshl_b32 s73, s13, 11
  s_lshl_b32 s14, s8, 14
  s_add_u32 s73, s73, s14
  s_lshl_b32 s14, s5, 9
  s_add_u32 s73, s73, s14
  s_add_u32 s73, s73, 131072
  s_mov_b32 s78, -1
  s_cmp_eq_u32 s5, 3
  s_cselect_b32 s79, 0, -1
  s_branch L_tsjh
L_tsfh:
  s_mul_i32 s13, s8, 48
  s_add_u32 s13, s13, 256
  v_min_u32 v7, 3, v6
  v_cmp_gt_u32 s[74:75], 4, v6
  v_lshlrev_b32 v192, 14, v5
  v_lshl_add_u32 v192, v4, 11, v192
  v_lshl_add_u32 v193, v7, 4, v192
  v_add_u32 v193, 128, v193
  v_lshl_add_u32 v192, v6, 4, v192
  s_sub_u32 s14, s4, 1
  s_lshl_b32 s76, s14, 14
  s_lshl_b32 s14, s13, 2
  s_add_u32 s76, s76, s14
  s_add_u32 s76, s76, 131072
  s_add_u32 s77, s76, 0x2000
  v_add_u32 v194, s13, v4
  v_lshl_add_u32 v195, v7, 2, v194
  v_add_u32 v195, 32, v195
  v_lshl_add_u32 v194, v6, 2, v194
  v_lshlrev_b32 v196, 13, v5
  v_lshl_add_u32 v197, v7, 4, v196
  v_add_u32 v197, 128, v197
  v_lshl_add_u32 v196, v6, 4, v196
  s_sub_u32 s14, s4, 1
  s_lshl_b32 s15, s14, 13
  s_lshl_b32 s13, s13, 2
  s_add_u32 s15, s15, s13
  s_add_u32 s67, s15, 65536
  s_mul_i32 s14, s14, 896
  s_add_u32 s64, s16, s14
  s_addc_u32 s65, s17, 0
  v_mul_u32_u24 v7, 448, v5
  v_add_lshl_u32 v194, v194, v7, 1
  v_add_lshl_u32 v195, v195, v7, 1
  v_mul_u32_u24 v201, 0x0202, v4
  v_add_u32 v201, 0x0100, v201
  v_lshlrev_b32 v201, 16, v201
  v_or_b32 v201, 0x0c0c, v201
  v_lshrrev_b32 v198, 1, v4
  v_lshlrev_b32 v198, 7, v198
  v_lshl_add_u32 v198, v5, 3, v198
  v_lshl_add_u32 v198, v6, 4, v198
  v_and_b32 v7, 1, v4
  v_lshl_add_u32 v198, v7, 9, v198
  s_lshl_b32 s14, s3, 10
  s_add_u32 s14, s14, 4096
  v_add_u32 v198, s14, v198
  v_lshlrev_b32 v200, 6, v5
  v_lshl_add_u32 v199, v7, 2, v200
  s_lshl_b32 s14, s3, 3
  v_add_u32 v199, s14, v199
  v_bfe_u32 v4, v1, 2, 1
  v_lshlrev_b32 v4, 4, v4
  v_mov_b32 v5, 0x3f80
  v_lshlrev_b32 v4, v4, v5
  v_and_b32 v5, 11, v1
  v_cmp_eq_u32 vcc, 0, v5
  s_nop 1
  v_cndmask_b32 v204, 0, v4, vcc
  v_mov_b32 v205, 0
  v_cmp_eq_u32 vcc, 8, v5
  s_nop 1
  v_cndmask_b32 v206, 0, v4, vcc
  v_mov_b32 v207, 0
  v_cmp_eq_u32 vcc, 1, v5
  s_nop 1
  v_cndmask_b32 v208, 0, v4, vcc
  v_mov_b32 v209, 0
  v_cmp_eq_u32 vcc, 9, v5
  s_nop 1
  v_cndmask_b32 v210, 0, v4, vcc
  v_mov_b32 v211, 0
  v_mov_b32 v212, 0
  v_mov_b32 v213, 0
  s_lshr_b32 s13, s7, 2
  s_lshl_b32 s13, s13, 13
  s_add_u32 s70, s76, s13
  s_and_b32 s13, s7, 3
  s_lshl_b32 s13, s13, 4
  s_lshl_b64 s[68:69], 0xffff, s13
L_tsjh:
  v_lshrrev_b32 v240, 5, v1
  v_lshlrev_b32 v241, 4, v240
  v_lshlrev_b32 v240, 9, v240
  v_bfe_u32 v4, v1, 1, 1
  v_lshl_add_u32 v240, v4, 8, v240
  v_bfe_u32 v4, v1, 2, 3
  v_lshl_add_u32 v240, v4, 4, v240
  v_and_b32 v4, 1, v1
  v_lshl_add_u32 v240, v4, 3, v240
  s_lshr_b32 s13, s8, 1
  s_lshl_b32 s13, s13, 10
  s_and_b32 s14, s8, 1
  s_lshl_b32 s14, s14, 7
  s_add_u32 s13, s13, s14
  v_add_u32 v240, s13, v240
  s_lshl_b32 s72, s4, 3
  s_add_u32 s72, s72, s7
  s_lshl_b32 s72, s72, 2
  s_add_u32 s72, s72, s8
  s_lshl_b32 s72, s72, 2
  s_add_u32 s72, s72, s5
  s_lshl_b32 s72, s72, 10
  s_add_u32 s72, s72, 1048576
  v_mov_b32 v24, 0
  v_mov_b32 v26, 0
  s_not_b32 s13, s45
  v_mov_b32 v25, s13
  v_mov_b32 v27, s13
  s_cmp_lt_u32 s47, 28
  s_cbranch_scc1 L_dutyf
  s_branch L_duty2
L_dutyf:
  v_bfe_u32 v5, v1, 3, 1
  v_and_b32 v6, 7, v1
  v_and_b32 v4, 15, v1
  v_lshlrev_b32 v234, 6, v4
  v_and_b32 v4, 1, v3
  v_lshl_add_u32 v234, v4, 5, v234
  v_lshrrev_b32 v4, 1, v3
  v_lshl_add_u32 v234, v4, 4, v234
  s_sub_u32 s14, s4, 1
  s_lshl_b32 s73, s14, 5
  s_add_u32 s73, s73, s47
  s_lshl_b32 s73, s73, 12
  s_lshl_b32 s13, s8, 10
  s_add_u32 s73, s73, s13
  s_add_u32 s73, s73, 2097152
  s_add_u32 s71, s73, 0x20000
  s_cmp_eq_u32 s8, 3
  s_cselect_b32 s78, 0x00ff00ff, -1
  s_mov_b32 s79, s78
  v_lshrrev_b32 v235, 3, v1
  v_lshlrev_b32 v235, 12, v235
  v_lshl_add_u32 v235, v6, 4, v235
  v_and_b32 v236, 0x3fff, v235
  s_and_b32 s13, s8, 1
  s_add_u32 s14, s14, s13
  s_lshl_b32 s80, s14, 17
  s_lshl_b32 s15, s47, 7
  s_add_u32 s80, s80, s15
  s_add_u32 s80, s80, 2097152
  s_add_u32 s81, s80, 0x8000
  s_add_u32 s82, s80, 0x10000
  s_add_u32 s83, s80, 0x18000
  s_lshl_b32 s15, s47, 5
  v_lshl_add_u32 v4, v6, 2, s15
  s_mul_i32 s15, s13, 896
  v_add_u32 v237, s15, v4
  s_lshl_b32 s15, s14, 13
  s_add_u32 s15, s15, 70912
  v_lshl_add_u32 v238, v4, 1, s15
  s_mul_i32 s15, s14, 896
  v_add_u32 v239, s15, v4
L_duty2:
  s_cmp_lg_u32 s8, 1
  s_cbranch_scc1 L_duty3
  s_lshr_b32 s13, s4, 1
  s_lshl_b32 s13, s13, 6
  s_add_u32 s13, s13, s7
  s_lshl_b32 s13, s13, 3
  s_add_u32 s14, s13, 2048
  v_and_b32 v4, 3, v1
  v_lshlrev_b32 v4, 6, v4
  s_getreg_b32 s15, hwreg(HW_REG_XCC_ID, 0, 4)
L_pollX:
  buffer_load_dwordx2 v[28:29], v4, s[48:51], s14 offen sc1
  s_waitcnt vmcnt(0)
  v_cmp_ne_u32 vcc, s45, v29
  s_cbranch_vccz L_gotX
  s_sub_u32 s84, s84, 1
  s_cbranch_scc1 L_fin
  s_branch L_pollX
L_gotX:
  v_cmp_ne_u32 vcc, s15, v28
  s_nop 0
  s_cmp_eq_u64 vcc, 0
  s_cselect_b32 s13, 2, 1
  v_mov_b32 v4, 0
  v_mov_b32 v5, s13
  ds_write_b32 v4, v5 offset:20
L_duty3:
  s_cmp_eq_u32 s8, 0
  s_cbranch_scc1 L_ml
  s_cmp_lg_u32 s8, 2
  s_cbranch_scc1 L_pre_x
  s_lshr_b32 s13, s2, 3
  s_cmp_ge_u32 s13, 26
  s_cbranch_scc1 L_nopfb
  s_getpc_b64 s[14:15]
L_pcb:
  s_sub_u32 s14, s14, L_pcb-L_start
  s_subb_u32 s15, s15, 0
  s_lshl_b32 s13, s13, 10
  v_add_u32 v54, s13, v2
  global_load_dwordx4 v[60:63], v54, s[14:15]
L_nopfb:
  s_cmp_lg_u32 s2, 0
  s_cbranch_scc1 L_pre_x
  s_movk_i32 s14, 2048
L_pollR:
  buffer_load_dwordx4 v[28:31], v2, s[48:51], s14 offen sc1
  buffer_load_dwordx4 v[32:35], v2, s[48:51], s14 offen offset:1024 sc1
  s_waitcnt vmcnt(0)
  v_xor_b32 v36, s45, v29
  v_xor_b32 v37, s45, v31
  v_bitop3_b32 v36, v36, v33, s45 bitop3:0xf6
  v_bitop3_b32 v37, v37, v35, s45 bitop3:0xf6
  v_or_b32 v36, v36, v37
  v_cmp_ne_u32 vcc, 0, v36
  s_cbranch_vccz L_gotR
  s_sub_u32 s84, s84, 1
  s_cbranch_scc1 L_fin
  s_branch L_pollR
L_gotR:
  s_add_u32 s44, s44, 1
  v_mov_b32 v28, 0
  v_mov_b32 v29, s44
  s_mov_b64 exec, 1
  buffer_store_dword v29, v28, s[48:51], 0 offen sc1
  s_mov_b64 exec, -1
  s_branch L_pre_x
L_ml:
  v_mov_b32 v54, 0
L_spin2:
  ds_read_b32 v55, v54 offset:4
  s_waitcnt lgkmcnt(0)
  v_readfirstlane_b32 s13, v55
  s_nop 0
  s_cmp_ge_u32 s13, 4
  s_cbranch_scc1 L_spun2
  s_sub_u32 s84, s84, 1
  s_cbranch_scc1 L_fin
  s_branch L_spin2
L_spun2:
  v_lshrrev_b32 v54, 1, v241
  v_add_u32 v54, 128, v54
  ds_read2_b64 v[36:39], v54 offset0:0 offset1:2
  ds_read2_b64 v[40:43], v54 offset0:4 offset1:6
  s_mov_b32 s15, 0x3db8aa3b
  s_lshl_b32 s13, s4, 3
  s_add_u32 s13, s13, s7
  s_lshl_b32 s13, s13, 2
  s_add_u32 s13, s13, s5
  s_lshl_b32 s13, s13, 7
  s_add_u32 s13, s13, 32768
  s_waitcnt lgkmcnt(0)
  v_max3_f32 v28, v36, v38, v40
  v_max_f32 v28, v28, v42
  v_sub_f32 v32, v36, v28
  v_mul_f32 v32, s15, v32
  v_exp_f32 v32, v32
  v_sub_f32 v33, v38, v28
  v_mul_f32 v33, s15, v33
  v_exp_f32 v33, v33
  v_sub_f32 v34, v40, v28
  v_mul_f32 v34, s15, v34
  v_exp_f32 v34, v34
  v_sub_f32 v35, v42, v28
  v_mul_f32 v35, s15, v35
  v_exp_f32 v35, v35
  v_mul_f32 v30, v32, v37
  v_fmac_f32 v30, v33, v39
  v_fmac_f32 v30, v34, v41
  v_fmac_f32 v30, v35, v43
  v_mov_b32 v29, s45
  v_mov_b32 v31, s45
  s_mov_b32 exec_lo, 1
  s_mov_b32 exec_hi, 1
  buffer_store_dwordx4 v[28:31], v241, s[48:51], s13 offen sc1
  s_mov_b64 exec, -1
  ds_write_b128 v241, v[32:35] offset:32
L_pre_x:
  v_mov_b32 v4, 0
L_spinL:
  ds_read_b32 v5, v4 offset:20
  s_waitcnt lgkmcnt(0)
  v_readfirstlane_b32 s13, v5
  s_nop 0
  s_cmp_ge_u32 s13, 1
  s_cbranch_scc1 L_spunL
  s_sub_u32 s84, s84, 1
  s_cbranch_scc1 L_fin
  s_branch L_spinL
L_spunL:
  s_mov_b32 s10, s13
  v_mov_b32 v9, s45
  v_mov_b32 v11, s45
  v_mov_b32 v13, s45
  v_mov_b32 v15, s45
  s_waitcnt vmcnt(0) lgkmcnt(0)
  s_barrier
  ds_read_b128 v[24:27], v241 offset:32
  ds_read_b64 v[56:57], v240 offset:19712
  ds_read_b64 v[58:59], v240 offset:21760
  ds_read_b64 v[60:61], v240 offset:23808
  ds_read_b64 v[62:63], v240 offset:25856
  s_waitcnt lgkmcnt(0)
  v_mul_f32 v8, v24, v56
  v_mul_f32 v10, v24, v57
  v_fmac_f32 v8, v25, v58
  v_fmac_f32 v10, v25, v59
  v_fmac_f32 v8, v26, v60
  v_fmac_f32 v10, v26, v61
  v_fmac_f32 v8, v27, v62
  v_fmac_f32 v10, v27, v63
  s_cmp_eq_u32 s10, 2
  s_cbranch_scc0 L_oafar
  buffer_store_dwordx4 v[8:11], v2, s[48:51], s72 offen
  s_branch L_oadone
L_oafar:
  buffer_store_dwordx4 v[8:11], v2, s[48:51], s72 offen sc1
L_oadone:
L_tail_s:
  s_barrier
  s_cmp_lt_u32 s47, 28
  s_cbranch_scc1 L_flfs
  s_bitcmp1_b32 s4, 0
  s_cbranch_scc1 L_fljs
  buffer_load_dwordx4 v[48:51], v193, s[48:51], s77 offen sc1
  buffer_load_dwordx4 v[32:35], v192, s[48:51], s76 offen offset:0 sc1
  buffer_load_dwordx4 v[36:39], v192, s[48:51], s76 offen offset:128 sc1
  buffer_load_dwordx4 v[40:43], v192, s[48:51], s76 offen offset:256 sc1
  buffer_load_dwordx4 v[44:47], v192, s[48:51], s76 offen offset:384 sc1
  s_branch L_fljs
L_flfs:
  global_load_short_d16_hi v212, v194, s[64:65]
  global_load_short_d16_hi v213, v195, s[64:65]
  buffer_load_dwordx4 v[32:35], v196, s[48:51], s67 offen offset:0 sc1
  buffer_load_dwordx4 v[36:39], v197, s[48:51], s67 offen offset:0 sc1
  buffer_load_dwordx4 v[40:43], v196, s[48:51], s67 offen offset:1792 sc1
  buffer_load_dwordx4 v[44:47], v197, s[48:51], s67 offen offset:1792 sc1
  buffer_load_dwordx4 v[48:51], v196, s[48:51], s67 offen offset:3584 sc1
  buffer_load_dwordx4 v[52:55], v197, s[48:51], s67 offen offset:3584 sc1
L_fljs:
L_tail:
  s_cmp_lt_u32 s47, 28
  s_cbranch_scc1 L_ffn
  s_bitcmp1_b32 s4, 0
  s_cbranch_scc1 L_fin
  s_mov_b32 s69, 0x3db8aa3b
  s_waitcnt vmcnt(4)
  v_xor_b32 v24, s45, v49
  v_xor_b32 v25, s45, v51
  v_or_b32 v24, v24, v25
  v_cmp_ne_u32 vcc, 0, v24
  s_cbranch_vccz L_mok
L_pollM:
  buffer_load_dwordx4 v[48:51], v193, s[48:51], s77 offen sc1
  s_waitcnt vmcnt(0)
  v_xor_b32 v24, s45, v49
  v_xor_b32 v25, s45, v51
  v_or_b32 v24, v24, v25
  v_cmp_ne_u32 vcc, 0, v24
  s_nop 0
  s_mov_b64 exec, vcc
  s_cbranch_execz L_gotM
  s_sub_u32 s84, s84, 1
  s_cbranch_scc1 L_fin
  s_branch L_pollM
L_gotM:
  s_mov_b64 exec, -1
L_mok:
  v_mov_b32 v52, v48
  v_mov_b32 v53, v52
  s_nop 1
  v_permlane16_swap_b32 v52, v53
  v_max_f32 v52, v52, v53
  v_mov_b32 v53, v52
  s_nop 1
  v_permlane32_swap_b32 v52, v53
  v_max_f32 v52, v52, v53
  v_sub_f32 v48, v48, v52
  v_mul_f32 v48, s69, v48
  v_exp_f32 v48, v48
  s_nop 0
  v_mul_f32 v52, v48, v50
  v_mov_b32 v53, v52
  s_nop 1
  v_permlane16_swap_b32 v52, v53
  v_add_f32 v52, v52, v53
  v_mov_b32 v53, v52
  s_nop 1
  v_permlane32_swap_b32 v52, v53
  v_add_f32 v52, v52, v53
  v_rcp_f32 v52, v52
  s_nop 0
  v_mul_f32 v48, v48, v52
  s_waitcnt vmcnt(0)
  v_xor_b32 v24, s45, v33
  v_xor_b32 v25, s45, v35
  v_bitop3_b32 v24, v24, v37, s45 bitop3:0xf6
  v_bitop3_b32 v25, v25, v39, s45 bitop3:0xf6
  v_bitop3_b32 v24, v24, v41, s45 bitop3:0xf6
  v_bitop3_b32 v25, v25, v43, s45 bitop3:0xf6
  v_bitop3_b32 v24, v24, v45, s45 bitop3:0xf6
  v_bitop3_b32 v25, v25, v47, s45 bitop3:0xf6
  v_or_b32 v24, v24, v25
  v_cmp_ne_u32 vcc, 0, v24
  s_nop 0
  s_mov_b64 exec, vcc
  s_cbranch_execz L_gotA
L_pollA:
  buffer_load_dwordx4 v[32:35], v192, s[48:51], s76 offen offset:0 sc1
  buffer_load_dwordx4 v[36:39], v192, s[48:51], s76 offen offset:128 sc1
  buffer_load_dwordx4 v[40:43], v192, s[48:51], s76 offen offset:256 sc1
  buffer_load_dwordx4 v[44:47], v192, s[48:51], s76 offen offset:384 sc1
  s_waitcnt vmcnt(0)
  v_xor_b32 v24, s45, v33
  v_xor_b32 v25, s45, v35
  v_bitop3_b32 v24, v24, v37, s45 bitop3:0xf6
  v_bitop3_b32 v25, v25, v39, s45 bitop3:0xf6
  v_bitop3_b32 v24, v24, v41, s45 bitop3:0xf6
  v_bitop3_b32 v25, v25, v43, s45 bitop3:0xf6
  v_bitop3_b32 v24, v24, v45, s45 bitop3:0xf6
  v_bitop3_b32 v25, v25, v47, s45 bitop3:0xf6
  v_or_b32 v24, v24, v25
  v_cmp_ne_u32 vcc, 0, v24
  s_nop 0
  s_mov_b64 exec, vcc
  s_cbranch_execz L_gotA
  s_sub_u32 s84, s84, 1
  s_cbranch_scc1 L_fin
  s_branch L_pollA
L_gotA:
  s_mov_b64 exec, -1
  v_mul_f32 v32, v32, v48
  v_mul_f32 v34, v34, v48
  v_mul_f32 v36, v36, v48
  v_mul_f32 v38, v38, v48
  v_mul_f32 v40, v40, v48
  v_mul_f32 v42, v42, v48
  v_mul_f32 v44, v44, v48
  v_mul_f32 v46, v46, v48
  v_permlane16_swap_b32 v32, v36
  v_permlane16_swap_b32 v40, v44
  v_permlane16_swap_b32 v34, v38
  v_permlane16_swap_b32 v42, v46
  v_add_f32 v32, v32, v36
  v_add_f32 v40, v40, v44
  v_add_f32 v34, v34, v38
  v_add_f32 v42, v42, v46
  v_permlane32_swap_b32 v32, v40
  s_nop 0
  v_permlane32_swap_b32 v34, v42
  v_add_f32 v32, v32, v40
  v_add_f32 v34, v34, v42
  v_cvt_pk_bf16_f32 v52, v32, v32
  v_cvt_pk_bf16_f32 v54, v34, v34
  s_nop 0
  v_mov_b32_dpp v53, v52 row_shl:4 row_mask:0xf bank_mask:0x5
  s_nop 1
  v_mov_b32_dpp v53, v52 row_shr:4 row_mask:0xf bank_mask:0xa
  v_mov_b32_dpp v55, v54 row_shl:4 row_mask:0xf bank_mask:0x5
  s_nop 1
  v_mov_b32_dpp v55, v54 row_shr:4 row_mask:0xf bank_mask:0xa
.p2align 3
  v_and_b32_dpp v224, v52, v16 quad_perm:[0,0,0,0] row_mask:0xf bank_mask:0xf
  v_and_b32_dpp v225, v52, v17 quad_perm:[0,0,0,0] row_mask:0xf bank_mask:0xf
  v_and_b32_dpp v226, v53, v18 quad_perm:[0,0,0,0] row_mask:0xf bank_mask:0xf
  v_and_b32_dpp v227, v53, v19 quad_perm:[0,0,0,0] row_mask:0xf bank_mask:0xf
  v_and_b32_dpp v228, v54, v16 quad_perm:[0,0,0,0] row_mask:0xf bank_mask:0xf
  v_and_b32_dpp v229, v54, v17 quad_perm:[0,0,0,0] row_mask:0xf bank_mask:0xf
  v_and_b32_dpp v230, v55, v18 quad_perm:[0,0,0,0] row_mask:0xf bank_mask:0xf
  v_and_b32_dpp v231, v55, v19 quad_perm:[0,0,0,0] row_mask:0xf bank_mask:0xf
  v_mfma_f32_16x16x32_bf16 v[20:23], v[224:227], v[128:131], 0
  v_and_b32_dpp v224, v52, v16 quad_perm:[1,1,1,1] row_mask:0xf bank_mask:0xf
  v_and_b32_dpp v225, v52, v17 quad_perm:[1,1,1,1] row_mask:0xf bank_mask:0xf
  v_and_b32_dpp v226, v53, v18 quad_perm:[1,1,1,1] row_mask:0xf bank_mask:0xf
  v_and_b32_dpp v227, v53, v19 quad_perm:[1,1,1,1] row_mask:0xf bank_mask:0xf
  v_mfma_f32_16x16x32_bf16 v[20:23], v[228:231], v[132:135], v[20:23]
  v_and_b32_dpp v228, v54, v16 quad_perm:[1,1,1,1] row_mask:0xf bank_mask:0xf
  v_and_b32_dpp v229, v54, v17 quad_perm:[1,1,1,1] row_mask:0xf bank_mask:0xf
  v_and_b32_dpp v230, v55, v18 quad_perm:[1,1,1,1] row_mask:0xf bank_mask:0xf
  v_and_b32_dpp v231, v55, v19 quad_perm:[1,1,1,1] row_mask:0xf bank_mask:0xf
  v_mfma_f32_16x16x32_bf16 v[20:23], v[224:227], v[136:139], v[20:23]
  v_and_b32_dpp v224, v52, v16 quad_perm:[2,2,2,2] row_mask:0xf bank_mask:0xf
  v_and_b32_dpp v225, v52, v17 quad_perm:[2,2,2,2] row_mask:0xf bank_mask:0xf
  v_and_b32_dpp v226, v53, v18 quad_perm:[2,2,2,2] row_mask:0xf bank_mask:0xf
  v_and_b32_dpp v227, v53, v19 quad_perm:[2,2,2,2] row_mask:0xf bank_mask:0xf
  v_mfma_f32_16x16x32_bf16 v[20:23], v[228:231], v[140:143], v[20:23]
  v_and_b32_dpp v228, v54, v16 quad_perm:[2,2,2,2] row_mask:0xf bank_mask:0xf
  v_and_b32_dpp v229, v54, v17 quad_perm:[2,2,2,2] row_mask:0xf bank_mask:0xf
  v_and_b32_dpp v230, v55, v18 quad_perm:[2,2,2,2] row_mask:0xf bank_mask:0xf
  v_and_b32_dpp v231, v55, v19 quad_perm:[2,2,2,2] row_mask:0xf bank_mask:0xf
  v_mfma_f32_16x16x32_bf16 v[20:23], v[224:227], v[144:147], v[20:23]
  v_and_b32_dpp v224, v52, v16 quad_perm:[3,3,3,3] row_mask:0xf bank_mask:0xf
  v_and_b32_dpp v225, v52, v17 quad_perm:[3,3,3,3] row_mask:0xf bank_mask:0xf
  v_and_b32_dpp v226, v53, v18 quad_perm:[3,3,3,3] row_mask:0xf bank_mask:0xf
  v_and_b32_dpp v227, v53, v19 quad_perm:[3,3,3,3] row_mask:0xf bank_mask:0xf
  v_mfma_f32_16x16x32_bf16 v[20:23], v[228:231], v[148:151], v[20:23]
  v_and_b32_dpp v228, v54, v16 quad_perm:[3,3,3,3] row_mask:0xf bank_mask:0xf
  v_and_b32_dpp v229, v54, v17 quad_perm:[3,3,3,3] row_mask:0xf bank_mask:0xf
  v_and_b32_dpp v230, v55, v18 quad_perm:[3,3,3,3] row_mask:0xf bank_mask:0xf
  v_and_b32_dpp v231, v55, v19 quad_perm:[3,3,3,3] row_mask:0xf bank_mask:0xf
  v_mfma_f32_16x16x32_bf16 v[20:23], v[224:227], v[152:155], v[20:23]
  v_and_b32_dpp v224, v53, v16 quad_perm:[0,0,0,0] row_mask:0xf bank_mask:0xf
  v_and_b32_dpp v225, v53, v17 quad_perm:[0,0,0,0] row_mask:0xf bank_mask:0xf
  v_and_b32_dpp v226, v52, v18 quad_perm:[0,0,0,0] row_mask:0xf bank_mask:0xf
  v_and_b32_dpp v227, v52, v19 quad_perm:[0,0,0,0] row_mask:0xf bank_mask:0xf
  v_mfma_f32_16x16x32_bf16 v[20:23], v[228:231], v[156:159], v[20:23]
  v_and_b32_dpp v228, v55, v16 quad_perm:[0,0,0,0] row_mask:0xf bank_mask:0xf
  v_and_b32_dpp v229, v55, v17 quad_perm:[0,0,0,0] row_mask:0xf bank_mask:0xf
  v_and_b32_dpp v230, v54, v18 quad_perm:[0,0,0,0] row_mask:0xf bank_mask:0xf
  v_and_b32_dpp v231, v54, v19 quad_perm:[0,0,0,0] row_mask:0xf bank_mask:0xf
  v_mfma_f32_16x16x32_bf16 v[20:23], v[224:227], v[160:163], v[20:23]
  v_and_b32_dpp v224, v53, v16 quad_perm:[1,1,1,1] row_mask:0xf bank_mask:0xf
  v_and_b32_dpp v225, v53, v17 quad_perm:[1,1,1,1] row_mask:0xf bank_mask:0xf
  v_and_b32_dpp v226, v52, v18 quad_perm:[1,1,1,1] row_mask:0xf bank_mask:0xf
  v_and_b32_dpp v227, v52, v19 quad_perm:[1,1,1,1] row_mask:0xf bank_mask:0xf
  v_mfma_f32_16x16x32_bf16 v[20:23], v[228:231], v[164:167], v[20:23]
  v_and_b32_dpp v228, v55, v16 quad_perm:[1,1,1,1] row_mask:0xf bank_mask:0xf
  v_and_b32_dpp v229, v55, v17 quad_perm:[1,1,1,1] row_mask:0xf bank_mask:0xf
  v_and_b32_dpp v230, v54, v18 quad_perm:[1,1,1,1] row_mask:0xf bank_mask:0xf
  v_and_b32_dpp v231, v54, v19 quad_perm:[1,1,1,1] row_mask:0xf bank_mask:0xf
  v_mfma_f32_16x16x32_bf16 v[20:23], v[224:227], v[168:171], v[20:23]
  v_and_b32_dpp v224, v53, v16 quad_perm:[2,2,2,2] row_mask:0xf bank_mask:0xf
  v_and_b32_dpp v225, v53, v17 quad_perm:[2,2,2,2] row_mask:0xf bank_mask:0xf
  v_and_b32_dpp v226, v52, v18 quad_perm:[2,2,2,2] row_mask:0xf bank_mask:0xf
  v_and_b32_dpp v227, v52, v19 quad_perm:[2,2,2,2] row_mask:0xf bank_mask:0xf
  v_mfma_f32_16x16x32_bf16 v[20:23], v[228:231], v[172:175], v[20:23]
  v_and_b32_dpp v228, v55, v16 quad_perm:[2,2,2,2] row_mask:0xf bank_mask:0xf
  v_and_b32_dpp v229, v55, v17 quad_perm:[2,2,2,2] row_mask:0xf bank_mask:0xf
  v_and_b32_dpp v230, v54, v18 quad_perm:[2,2,2,2] row_mask:0xf bank_mask:0xf
  v_and_b32_dpp v231, v54, v19 quad_perm:[2,2,2,2] row_mask:0xf bank_mask:0xf
  v_mfma_f32_16x16x32_bf16 v[20:23], v[224:227], v[176:179], v[20:23]
  v_and_b32_dpp v224, v53, v16 quad_perm:[3,3,3,3] row_mask:0xf bank_mask:0xf
  v_and_b32_dpp v225, v53, v17 quad_perm:[3,3,3,3] row_mask:0xf bank_mask:0xf
  v_and_b32_dpp v226, v52, v18 quad_perm:[3,3,3,3] row_mask:0xf bank_mask:0xf
  v_and_b32_dpp v227, v52, v19 quad_perm:[3,3,3,3] row_mask:0xf bank_mask:0xf
  v_mfma_f32_16x16x32_bf16 v[20:23], v[228:231], v[180:183], v[20:23]
  v_and_b32_dpp v228, v55, v16 quad_perm:[3,3,3,3] row_mask:0xf bank_mask:0xf
  v_and_b32_dpp v229, v55, v17 quad_perm:[3,3,3,3] row_mask:0xf bank_mask:0xf
  v_and_b32_dpp v230, v54, v18 quad_perm:[3,3,3,3] row_mask:0xf bank_mask:0xf
  v_and_b32_dpp v231, v54, v19 quad_perm:[3,3,3,3] row_mask:0xf bank_mask:0xf
  v_mfma_f32_16x16x32_bf16 v[20:23], v[224:227], v[184:187], v[20:23]
  s_nop 0
  v_mfma_f32_16x16x32_bf16 v[20:23], v[228:231], v[188:191], v[20:23]
  s_nop 7
  ds_write_b128 v194, v[20:23] offset:4096
  s_waitcnt lgkmcnt(0)
  s_barrier
  s_sub_u32 s13, s3, 4
  s_cmp_ge_u32 s13, 2
  s_cbranch_scc1 L_ypub
  ds_read2st64_b64 v[32:35], v195 offset0:0 offset1:2
  ds_read2st64_b64 v[36:39], v195 offset0:4 offset1:6
  ds_read2st64_b64 v[40:43], v195 offset0:8 offset1:10
  ds_read2st64_b64 v[44:47], v195 offset0:12 offset1:14
  s_mov_b64 exec, s[78:79]
  s_waitcnt lgkmcnt(0)
  v_pk_add_f32 v[32:33], v[32:33], v[34:35]
  v_pk_add_f32 v[36:37], v[36:37], v[38:39]
  v_pk_add_f32 v[40:41], v[40:41], v[42:43]
  v_pk_add_f32 v[44:45], v[44:45], v[46:47]
  v_pk_add_f32 v[32:33], v[32:33], v[36:37]
  v_pk_add_f32 v[40:41], v[40:41], v[44:45]
  v_pk_add_f32 v[32:33], v[32:33], v[40:41]
  v_cvt_pk_bf16_f32 v8, v32, v33
  buffer_store_dwordx2 v[8:9], v196, s[48:51], s73 offen sc1
L_ypub:
  s_branch L_fin
L_ffn:
  s_waitcnt vmcnt(0)
  v_xor_b32 v24, s45, v33
  v_xor_b32 v25, s45, v35
  v_bitop3_b32 v24, v24, v37, s45 bitop3:0xf6
  v_bitop3_b32 v25, v25, v39, s45 bitop3:0xf6
  v_bitop3_b32 v24, v24, v41, s45 bitop3:0xf6
  v_bitop3_b32 v25, v25, v43, s45 bitop3:0xf6
  v_bitop3_b32 v24, v24, v45, s45 bitop3:0xf6
  v_bitop3_b32 v25, v25, v47, s45 bitop3:0xf6
  v_bitop3_b32 v24, v24, v49, s45 bitop3:0xf6
  v_bitop3_b32 v25, v25, v51, s45 bitop3:0xf6
  v_bitop3_b32 v24, v24, v53, s45 bitop3:0xf6
  v_bitop3_b32 v25, v25, v55, s45 bitop3:0xf6
  v_or_b32 v24, v24, v25
  v_cmp_ne_u32 vcc, 0, v24
  s_nop 0
  s_mov_b64 exec, vcc
  s_cbranch_execz L_gotG
L_pollG:
  buffer_load_dwordx4 v[32:35], v196, s[48:51], s67 offen offset:0 sc1
  buffer_load_dwordx4 v[36:39], v197, s[48:51], s67 offen offset:0 sc1
  buffer_load_dwordx4 v[40:43], v196, s[48:51], s67 offen offset:1792 sc1
  buffer_load_dwordx4 v[44:47], v197, s[48:51], s67 offen offset:1792 sc1
  buffer_load_dwordx4 v[48:51], v196, s[48:51], s67 offen offset:3584 sc1
  buffer_load_dwordx4 v[52:55], v197, s[48:51], s67 offen offset:3584 sc1
  s_waitcnt vmcnt(0)
  v_xor_b32 v24, s45, v33
  v_xor_b32 v25, s45, v35
  v_bitop3_b32 v24, v24, v37, s45 bitop3:0xf6
  v_bitop3_b32 v25, v25, v39, s45 bitop3:0xf6
  v_bitop3_b32 v24, v24, v41, s45 bitop3:0xf6
  v_bitop3_b32 v25, v25, v43, s45 bitop3:0xf6
  v_bitop3_b32 v24, v24, v45, s45 bitop3:0xf6
  v_bitop3_b32 v25, v25, v47, s45 bitop3:0xf6
  v_bitop3_b32 v24, v24, v49, s45 bitop3:0xf6
  v_bitop3_b32 v25, v25, v51, s45 bitop3:0xf6
  v_bitop3_b32 v24, v24, v53, s45 bitop3:0xf6
  v_bitop3_b32 v25, v25, v55, s45 bitop3:0xf6
  v_or_b32 v24, v24, v25
  v_cmp_ne_u32 vcc, 0, v24
  s_nop 0
  s_mov_b64 exec, vcc
  s_cbranch_execz L_gotG
  s_sub_u32 s84, s84, 1
  s_cbranch_scc1 L_fin
  s_branch L_pollG
L_gotG:
  s_mov_b64 exec, -1
  v_perm_b32 v214, v34, v32, v201
  v_perm_b32 v215, v38, v36, v201
  v_perm_b32 v216, v42, v40, v201
  v_perm_b32 v217, v46, v44, v201
  v_perm_b32 v218, v50, v48, v201
  v_perm_b32 v219, v54, v52, v201
  v_add_f32 v218, 1.0, v218
  v_add_f32 v219, 1.0, v219
  v_cvt_pk_bf16_f32 v4, v218, v219
  v_lshlrev_b32 v218, 16, v4
  v_and_b32 v219, s46, v4
  s_cmp_lt_u32 s3, 6
  s_cbranch_scc1 L_nogb
L_pollB:
  buffer_load_dwordx2 v[62:63], v238, s[48:51], 0 offen sc1
  s_waitcnt vmcnt(0)
  v_cmp_ne_u32 vcc, s45, v63
  s_cbranch_vccz L_nogb
  s_sub_u32 s84, s84, 1
  s_cbranch_scc1 L_fin
  s_branch L_pollB
L_nogb:
  s_mov_b64 exec, s[68:69]
L_pollP:
  buffer_load_dwordx4 v[32:35], v192, s[48:51], s70 offen sc1
  s_waitcnt vmcnt(0)
  v_xor_b32 v24, s45, v33
  v_xor_b32 v25, s45, v35
  v_or_b32 v24, v24, v25
  v_cmp_ne_u32 vcc, 0, v24
  s_nop 0
  s_mov_b64 exec, vcc
  s_cbranch_execz L_gotP
  s_sub_u32 s84, s84, 1
  s_cbranch_scc1 L_fin
  s_branch L_pollP
L_gotP:
  s_mov_b64 exec, -1
L_pollY:
  buffer_load_dwordx4 v[32:35], v192, s[48:51], s76 offen sc1
  buffer_load_dwordx4 v[36:39], v193, s[48:51], s76 offen sc1
  buffer_load_dwordx4 v[40:43], v192, s[48:51], s77 offen sc1
  buffer_load_dwordx4 v[44:47], v193, s[48:51], s77 offen sc1
  s_waitcnt vmcnt(0)
  v_xor_b32 v24, s45, v33
  v_xor_b32 v25, s45, v35
  v_bitop3_b32 v24, v24, v37, s45 bitop3:0xf6
  v_bitop3_b32 v25, v25, v39, s45 bitop3:0xf6
  v_bitop3_b32 v24, v24, v41, s45 bitop3:0xf6
  v_bitop3_b32 v25, v25, v43, s45 bitop3:0xf6
  v_bitop3_b32 v24, v24, v45, s45 bitop3:0xf6
  v_bitop3_b32 v25, v25, v47, s45 bitop3:0xf6
  v_or_b32 v24, v24, v25
  v_cmp_ne_u32 vcc, 0, v24
  s_nop 0
  s_mov_b64 exec, vcc
  s_cbranch_execz L_gotY
  s_sub_u32 s84, s84, 1
  s_cbranch_scc1 L_fin
  s_branch L_pollY
L_gotY:
  s_mov_b64 exec, -1
  v_mfma_f32_16x16x32_bf16 v[24:27], v[204:207], v[32:35], 0
  v_mfma_f32_16x16x32_bf16 v[24:27], v[208:211], v[36:39], v[24:27]
  v_mfma_f32_16x16x32_bf16 v[24:27], v[204:207], v[40:43], v[24:27]
  v_mfma_f32_16x16x32_bf16 v[24:27], v[208:211], v[44:47], v[24:27]
  s_nop 7
  v_cvt_pk_bf16_f32 v4, v24, v25
  v_lshlrev_b32 v24, 16, v4
  v_and_b32 v25, s46, v4
  v_pk_mul_f32 v[24:25], v[24:25], v[214:215]
  v_cvt_pk_bf16_f32 v4, v24, v25
  v_lshlrev_b32 v24, 16, v4
  v_and_b32 v25, s46, v4
  v_pk_add_f32 v[24:25], v[24:25], v[212:213]
  v_cvt_pk_bf16_f32 v4, v24, v25
  v_lshlrev_b32 v24, 16, v4
  v_and_b32 v25, s46, v4
  v_cndmask_b32 v5, 0, v25, s[74:75]
  v_add_f32 v6, v24, v5
  v_mul_f32 v7, v24, v24
  v_fmac_f32 v7, v5, v5
  ds_write_b16 v194, v4 offset:1536
  ds_write_b16_d16_hi v195, v4 offset:1536
  v_add_f32_dpp v6, v6, v6 quad_perm:[1,0,3,2] row_mask:0xf bank_mask:0xf
  v_add_f32_dpp v7, v7, v7 quad_perm:[1,0,3,2] row_mask:0xf bank_mask:0xf
  s_nop 0
  v_add_f32_dpp v6, v6, v6 quad_perm:[2,3,0,1] row_mask:0xf bank_mask:0xf
  v_add_f32_dpp v7, v7, v7 quad_perm:[2,3,0,1] row_mask:0xf bank_mask:0xf
  s_nop 0
  v_add_f32_dpp v6, v6, v6 row_half_mirror row_mask:0xf bank_mask:0xf
  v_add_f32_dpp v7, v7, v7 row_half_mirror row_mask:0xf bank_mask:0xf
  s_nop 1
  v_permlane16_swap_b32 v6, v7
  v_add_f32 v6, v6, v7
  v_mov_b32 v7, v6
  s_nop 1
  v_permlane32_swap_b32 v6, v7
  v_add_f32 v6, v6, v7
  s_mov_b64 exec, 0x01010101
  ds_write_b32 v199, v6 offset:1280
  s_mov_b64 exec, -1
  s_waitcnt lgkmcnt(0)
  s_barrier
  ds_read_b128 v[32:35], v200 offset:1280
  ds_read_b128 v[36:39], v200 offset:1296
  ds_read_b128 v[40:43], v200 offset:1312
  ds_read_b128 v[44:47], v200 offset:1328
  s_mov_b32 s69, 0x3b124925
  s_waitcnt lgkmcnt(0)
  v_pk_add_f32 v[32:33], v[32:33], v[34:35]
  v_pk_add_f32 v[36:37], v[36:37], v[38:39]
  v_pk_add_f32 v[40:41], v[40:41], v[42:43]
  v_pk_add_f32 v[44:45], v[44:45], v[46:47]
  v_pk_add_f32 v[32:33], v[32:33], v[36:37]
  v_pk_add_f32 v[40:41], v[40:41], v[44:45]
  v_pk_add_f32 v[32:33], v[32:33], v[40:41]
  v_mul_f32 v32, s69, v32
  v_mul_f32 v33, s69, v33
  v_fma_f32 v33, -v32, v32, v33
  v_max_f32 v33, 0, v33
  v_cvt_pk_bf16_f32 v4, v32, v33
  v_lshlrev_b32 v32, 16, v4
  v_and_b32 v33, s46, v4
  v_add_f32 v33, 0x3727c5ac, v33
  v_sub_f32 v24, v24, v32
  v_sub_f32 v25, v25, v32
  v_cvt_pk_bf16_f32 v33, v33, v33
  v_and_b32 v33, s46, v33
  v_cvt_pk_bf16_f32 v4, v24, v25
  v_lshlrev_b32 v24, 16, v4
  v_and_b32 v25, s46, v4
  v_sqrt_f32 v33, v33
  s_nop 0
  v_cvt_pk_bf16_f32 v33, v33, v33
  v_and_b32 v33, s46, v33
  v_rcp_f32 v33, v33
  s_nop 0
  v_mul_f32 v24, v24, v33
  v_mul_f32 v25, v25, v33
  v_cvt_pk_bf16_f32 v4, v24, v25
  v_lshlrev_b32 v24, 16, v4
  v_and_b32 v25, s46, v4
  v_pk_mul_f32 v[24:25], v[24:25], v[218:219]
  v_cvt_pk_bf16_f32 v4, v24, v25
  v_lshlrev_b32 v24, 16, v4
  v_and_b32 v25, s46, v4
  v_pk_add_f32 v[24:25], v[24:25], v[216:217]
  v_cvt_pk_bf16_f32 v52, v24, v24
  v_cvt_pk_bf16_f32 v54, v25, v25
  s_nop 0
  v_mov_b32_dpp v53, v52 row_shl:4 row_mask:0xf bank_mask:0x5
  s_nop 1
  v_mov_b32_dpp v53, v52 row_shr:4 row_mask:0xf bank_mask:0xa
  v_mov_b32_dpp v55, v54 row_shl:4 row_mask:0xf bank_mask:0x5
  s_nop 1
  v_mov_b32_dpp v55, v54 row_shr:4 row_mask:0xf bank_mask:0xa
  s_cmp_ge_u32 s3, 4
.p2align 3
  v_and_b32_dpp v224, v52, v16 quad_perm:[0,0,0,0] row_mask:0xf bank_mask:0xf
  v_and_b32_dpp v225, v52, v17 quad_perm:[0,0,0,0] row_mask:0xf bank_mask:0xf
  v_and_b32_dpp v226, v53, v18 quad_perm:[0,0,0,0] row_mask:0xf bank_mask:0xf
  v_and_b32_dpp v227, v53, v19 quad_perm:[0,0,0,0] row_mask:0xf bank_mask:0xf
  v_and_b32_dpp v228, v52, v16 quad_perm:[1,1,1,1] row_mask:0xf bank_mask:0xf
  v_and_b32_dpp v229, v52, v17 quad_perm:[1,1,1,1] row_mask:0xf bank_mask:0xf
  v_and_b32_dpp v230, v53, v18 quad_perm:[1,1,1,1] row_mask:0xf bank_mask:0xf
  v_and_b32_dpp v231, v53, v19 quad_perm:[1,1,1,1] row_mask:0xf bank_mask:0xf
  v_mfma_f32_16x16x32_bf16 v[20:23], v[224:227], v[128:131], 0
  v_and_b32_dpp v224, v52, v16 quad_perm:[2,2,2,2] row_mask:0xf bank_mask:0xf
  v_and_b32_dpp v225, v52, v17 quad_perm:[2,2,2,2] row_mask:0xf bank_mask:0xf
  v_and_b32_dpp v226, v53, v18 quad_perm:[2,2,2,2] row_mask:0xf bank_mask:0xf
  v_and_b32_dpp v227, v53, v19 quad_perm:[2,2,2,2] row_mask:0xf bank_mask:0xf
  v_mfma_f32_16x16x32_bf16 v[20:23], v[228:231], v[132:135], v[20:23]
  v_and_b32_dpp v228, v52, v16 quad_perm:[3,3,3,3] row_mask:0xf bank_mask:0xf
  v_and_b32_dpp v229, v52, v17 quad_perm:[3,3,3,3] row_mask:0xf bank_mask:0xf
  v_and_b32_dpp v230, v53, v18 quad_perm:[3,3,3,3] row_mask:0xf bank_mask:0xf
  v_and_b32_dpp v231, v53, v19 quad_perm:[3,3,3,3] row_mask:0xf bank_mask:0xf
  v_mfma_f32_16x16x32_bf16 v[20:23], v[224:227], v[136:139], v[20:23]
  v_and_b32_dpp v224, v53, v16 quad_perm:[0,0,0,0] row_mask:0xf bank_mask:0xf
  v_and_b32_dpp v225, v53, v17 quad_perm:[0,0,0,0] row_mask:0xf bank_mask:0xf
  v_and_b32_dpp v226, v52, v18 quad_perm:[0,0,0,0] row_mask:0xf bank_mask:0xf
  v_and_b32_dpp v227, v52, v19 quad_perm:[0,0,0,0] row_mask:0xf bank_mask:0xf
  v_mfma_f32_16x16x32_bf16 v[20:23], v[228:231], v[140:143], v[20:23]
  v_and_b32_dpp v228, v53, v16 quad_perm:[1,1,1,1] row_mask:0xf bank_mask:0xf
  v_and_b32_dpp v229, v53, v17 quad_perm:[1,1,1,1] row_mask:0xf bank_mask:0xf
  v_and_b32_dpp v230, v52, v18 quad_perm:[1,1,1,1] row_mask:0xf bank_mask:0xf
  v_and_b32_dpp v231, v52, v19 quad_perm:[1,1,1,1] row_mask:0xf bank_mask:0xf
  v_mfma_f32_16x16x32_bf16 v[20:23], v[224:227], v[144:147], v[20:23]
  v_and_b32_dpp v224, v53, v16 quad_perm:[2,2,2,2] row_mask:0xf bank_mask:0xf
  v_and_b32_dpp v225, v53, v17 quad_perm:[2,2,2,2] row_mask:0xf bank_mask:0xf
  v_and_b32_dpp v226, v52, v18 quad_perm:[2,2,2,2] row_mask:0xf bank_mask:0xf
  v_and_b32_dpp v227, v52, v19 quad_perm:[2,2,2,2] row_mask:0xf bank_mask:0xf
  v_mfma_f32_16x16x32_bf16 v[20:23], v[228:231], v[148:151], v[20:23]
  v_and_b32_dpp v228, v53, v16 quad_perm:[3,3,3,3] row_mask:0xf bank_mask:0xf
  v_and_b32_dpp v229, v53, v17 quad_perm:[3,3,3,3] row_mask:0xf bank_mask:0xf
  v_and_b32_dpp v230, v52, v18 quad_perm:[3,3,3,3] row_mask:0xf bank_mask:0xf
  v_and_b32_dpp v231, v52, v19 quad_perm:[3,3,3,3] row_mask:0xf bank_mask:0xf
  v_mfma_f32_16x16x32_bf16 v[20:23], v[224:227], v[152:155], v[20:23]
  v_and_b32_dpp v224, v54, v16 quad_perm:[0,0,0,0] row_mask:0xf bank_mask:0xf
  v_and_b32_dpp v225, v54, v17 quad_perm:[0,0,0,0] row_mask:0xf bank_mask:0xf
  v_and_b32_dpp v226, v55, v18 quad_perm:[0,0,0,0] row_mask:0xf bank_mask:0xf
  v_and_b32_dpp v227, v55, v19 quad_perm:[0,0,0,0] row_mask:0xf bank_mask:0xf
  v_mfma_f32_16x16x32_bf16 v[20:23], v[228:231], v[156:159], v[20:23]
  v_and_b32_dpp v228, v54, v16 quad_perm:[1,1,1,1] row_mask:0xf bank_mask:0xf
  v_and_b32_dpp v229, v54, v17 quad_perm:[1,1,1,1] row_mask:0xf bank_mask:0xf
  v_and_b32_dpp v230, v55, v18 quad_perm:[1,1,1,1] row_mask:0xf bank_mask:0xf
  v_and_b32_dpp v231, v55, v19 quad_perm:[1,1,1,1] row_mask:0xf bank_mask:0xf
  v_mfma_f32_16x16x32_bf16 v[20:23], v[224:227], v[160:163], v[20:23]
  v_and_b32_dpp v224, v54, v16 quad_perm:[2,2,2,2] row_mask:0xf bank_mask:0xf
  v_and_b32_dpp v225, v54, v17 quad_perm:[2,2,2,2] row_mask:0xf bank_mask:0xf
  v_and_b32_dpp v226, v55, v18 quad_perm:[2,2,2,2] row_mask:0xf bank_mask:0xf
  v_and_b32_dpp v227, v55, v19 quad_perm:[2,2,2,2] row_mask:0xf bank_mask:0xf
  v_mfma_f32_16x16x32_bf16 v[20:23], v[228:231], v[164:167], v[20:23]
  v_and_b32_dpp v228, v54, v16 quad_perm:[3,3,3,3] row_mask:0xf bank_mask:0xf
  v_and_b32_dpp v229, v54, v17 quad_perm:[3,3,3,3] row_mask:0xf bank_mask:0xf
  v_and_b32_dpp v230, v55, v18 quad_perm:[3,3,3,3] row_mask:0xf bank_mask:0xf
  v_and_b32_dpp v231, v55, v19 quad_perm:[3,3,3,3] row_mask:0xf bank_mask:0xf
  v_mfma_f32_16x16x32_bf16 v[20:23], v[224:227], v[168:171], v[20:23]
  v_and_b32_dpp v224, v55, v16 quad_perm:[0,0,0,0] row_mask:0xf bank_mask:0xf
  v_and_b32_dpp v225, v55, v17 quad_perm:[0,0,0,0] row_mask:0xf bank_mask:0xf
  v_and_b32_dpp v226, v54, v18 quad_perm:[0,0,0,0] row_mask:0xf bank_mask:0xf
  v_and_b32_dpp v227, v54, v19 quad_perm:[0,0,0,0] row_mask:0xf bank_mask:0xf
  v_mfma_f32_16x16x32_bf16 v[20:23], v[228:231], v[172:175], v[20:23]
  s_cbranch_scc1 L_gu
  v_and_b32_dpp v228, v55, v16 quad_perm:[1,1,1,1] row_mask:0xf bank_mask:0xf
  v_and_b32_dpp v229, v55, v17 quad_perm:[1,1,1,1] row_mask:0xf bank_mask:0xf
  v_and_b32_dpp v230, v54, v18 quad_perm:[1,1,1,1] row_mask:0xf bank_mask:0xf
  v_and_b32_dpp v231, v54, v19 quad_perm:[1,1,1,1] row_mask:0xf bank_mask:0xf
  v_mfma_f32_16x16x32_bf16 v[20:23], v[224:227], v[176:179], v[20:23]
  v_and_b32_dpp v224, v55, v16 quad_perm:[2,2,2,2] row_mask:0xf bank_mask:0xf
  v_and_b32_dpp v225, v55, v17 quad_perm:[2,2,2,2] row_mask:0xf bank_mask:0xf
  v_and_b32_dpp v226, v54, v18 quad_perm:[2,2,2,2] row_mask:0xf bank_mask:0xf
  v_and_b32_dpp v227, v54, v19 quad_perm:[2,2,2,2] row_mask:0xf bank_mask:0xf
  v_mfma_f32_16x16x32_bf16 v[20:23], v[228:231], v[180:183], v[20:23]
  v_and_b32_dpp v228, v55, v16 quad_perm:[3,3,3,3] row_mask:0xf bank_mask:0xf
  v_and_b32_dpp v229, v55, v17 quad_perm:[3,3,3,3] row_mask:0xf bank_mask:0xf
  v_and_b32_dpp v230, v54, v18 quad_perm:[3,3,3,3] row_mask:0xf bank_mask:0xf
  v_and_b32_dpp v231, v54, v19 quad_perm:[3,3,3,3] row_mask:0xf bank_mask:0xf
  v_mfma_f32_16x16x32_bf16 v[20:23], v[224:227], v[184:187], v[20:23]
  s_nop 0
  v_mfma_f32_16x16x32_bf16 v[20:23], v[228:231], v[188:191], v[20:23]
L_gu:
  s_nop 7
  ds_write2_b64 v198, v[20:21], v[22:23] offset0:0 offset1:32
  s_waitcnt lgkmcnt(0)
  s_barrier
  s_cmp_lt_u32 s3, 4
  s_cbranch_scc1 L_fin
  ds_read_b128 v[24:27], v2 offset:4096
  ds_read_b128 v[28:31], v2 offset:5120
  ds_read_b128 v[32:35], v2 offset:6144
  ds_read_b128 v[36:39], v2 offset:7168
  ds_read_b128 v[40:43], v2 offset:8192
  ds_read_b128 v[44:47], v2 offset:9216
  ds_read_b128 v[48:51], v2 offset:10240
  ds_read_b128 v[52:55], v2 offset:11264
  ds_read_b32 v60, v237 offset:1536
  s_mov_b32 s13, 0xbfb8aa3b
  s_waitcnt lgkmcnt(0)
  v_pk_add_f32 v[24:25], v[24:25], v[28:29]
  v_pk_add_f32 v[26:27], v[26:27], v[30:31]
  v_pk_add_f32 v[32:33], v[32:33], v[36:37]
  v_pk_add_f32 v[34:35], v[34:35], v[38:39]
  v_pk_add_f32 v[40:41], v[40:41], v[44:45]
  v_pk_add_f32 v[42:43], v[42:43], v[46:47]
  v_pk_add_f32 v[48:49], v[48:49], v[52:53]
  v_pk_add_f32 v[50:51], v[50:51], v[54:55]
  v_pk_add_f32 v[24:25], v[24:25], v[32:33]
  v_pk_add_f32 v[26:27], v[26:27], v[34:35]
  v_pk_add_f32 v[40:41], v[40:41], v[48:49]
  v_pk_add_f32 v[42:43], v[42:43], v[50:51]
  v_pk_add_f32 v[24:25], v[24:25], v[40:41]
  v_pk_add_f32 v[26:27], v[26:27], v[42:43]
  v_cvt_pk_bf16_f32 v4, v24, v25
  v_lshlrev_b32 v24, 16, v4
  v_and_b32 v25, s46, v4
  v_mul_f32 v24, s13, v24
  v_mul_f32 v25, s13, v25
  v_exp_f32 v24, v24
  v_exp_f32 v25, v25
  v_cvt_pk_bf16_f32 v5, v26, v27
  v_lshlrev_b32 v26, 16, v5
  v_and_b32 v27, s46, v5
  v_add_f32 v24, 1.0, v24
  v_add_f32 v25, 1.0, v25
  v_rcp_f32 v24, v24
  v_rcp_f32 v25, v25
  s_nop 0
  v_cvt_pk_bf16_f32 v4, v24, v25
  v_lshlrev_b32 v24, 16, v4
  v_and_b32 v25, s46, v4
  v_pk_mul_f32 v[24:25], v[24:25], v[26:27]
  v_cvt_pk_bf16_f32 v52, v24, v24
  v_cvt_pk_bf16_f32 v54, v25, v25
  s_nop 0
  v_mov_b32_dpp v53, v52 row_shl:4 row_mask:0xf bank_mask:0x5
  s_nop 1
  v_mov_b32_dpp v53, v52 row_shr:4 row_mask:0xf bank_mask:0xa
  v_mov_b32_dpp v55, v54 row_shl:4 row_mask:0xf bank_mask:0x5
  s_nop 1
  v_mov_b32_dpp v55, v54 row_shr:4 row_mask:0xf bank_mask:0xa
.p2align 3
  v_and_b32_dpp v224, v52, v16 quad_perm:[0,0,0,0] row_mask:0xf bank_mask:0xf
  v_and_b32_dpp v225, v52, v17 quad_perm:[0,0,0,0] row_mask:0xf bank_mask:0xf
  v_and_b32_dpp v226, v53, v18 quad_perm:[0,0,0,0] row_mask:0xf bank_mask:0xf
  v_and_b32_dpp v227, v53, v19 quad_perm:[0,0,0,0] row_mask:0xf bank_mask:0xf
  v_and_b32_dpp v228, v54, v16 quad_perm:[0,0,0,0] row_mask:0xf bank_mask:0xf
  v_and_b32_dpp v229, v54, v17 quad_perm:[0,0,0,0] row_mask:0xf bank_mask:0xf
  v_and_b32_dpp v230, v55, v18 quad_perm:[0,0,0,0] row_mask:0xf bank_mask:0xf
  v_and_b32_dpp v231, v55, v19 quad_perm:[0,0,0,0] row_mask:0xf bank_mask:0xf
  v_mfma_f32_16x16x32_bf16 v[20:23], v[224:227], v[64:67], 0
  v_and_b32_dpp v224, v52, v16 quad_perm:[1,1,1,1] row_mask:0xf bank_mask:0xf
  v_and_b32_dpp v225, v52, v17 quad_perm:[1,1,1,1] row_mask:0xf bank_mask:0xf
  v_and_b32_dpp v226, v53, v18 quad_perm:[1,1,1,1] row_mask:0xf bank_mask:0xf
  v_and_b32_dpp v227, v53, v19 quad_perm:[1,1,1,1] row_mask:0xf bank_mask:0xf
  v_mfma_f32_16x16x32_bf16 v[20:23], v[228:231], v[68:71], v[20:23]
  v_and_b32_dpp v228, v54, v16 quad_perm:[1,1,1,1] row_mask:0xf bank_mask:0xf
  v_and_b32_dpp v229, v54, v17 quad_perm:[1,1,1,1] row_mask:0xf bank_mask:0xf
  v_and_b32_dpp v230, v55, v18 quad_perm:[1,1,1,1] row_mask:0xf bank_mask:0xf
  v_and_b32_dpp v231, v55, v19 quad_perm:[1,1,1,1] row_mask:0xf bank_mask:0xf
  v_mfma_f32_16x16x32_bf16 v[20:23], v[224:227], v[72:75], v[20:23]
  v_and_b32_dpp v224, v52, v16 quad_perm:[2,2,2,2] row_mask:0xf bank_mask:0xf
  v_and_b32_dpp v225, v52, v17 quad_perm:[2,2,2,2] row_mask:0xf bank_mask:0xf
  v_and_b32_dpp v226, v53, v18 quad_perm:[2,2,2,2] row_mask:0xf bank_mask:0xf
  v_and_b32_dpp v227, v53, v19 quad_perm:[2,2,2,2] row_mask:0xf bank_mask:0xf
  v_mfma_f32_16x16x32_bf16 v[20:23], v[228:231], v[76:79], v[20:23]
  v_and_b32_dpp v228, v54, v16 quad_perm:[2,2,2,2] row_mask:0xf bank_mask:0xf
  v_and_b32_dpp v229, v54, v17 quad_perm:[2,2,2,2] row_mask:0xf bank_mask:0xf
  v_and_b32_dpp v230, v55, v18 quad_perm:[2,2,2,2] row_mask:0xf bank_mask:0xf
  v_and_b32_dpp v231, v55, v19 quad_perm:[2,2,2,2] row_mask:0xf bank_mask:0xf
  v_mfma_f32_16x16x32_bf16 v[20:23], v[224:227], v[80:83], v[20:23]
  v_and_b32_dpp v224, v52, v16 quad_perm:[3,3,3,3] row_mask:0xf bank_mask:0xf
  v_and_b32_dpp v225, v52, v17 quad_perm:[3,3,3,3] row_mask:0xf bank_mask:0xf
  v_and_b32_dpp v226, v53, v18 quad_perm:[3,3,3,3] row_mask:0xf bank_mask:0xf
  v_and_b32_dpp v227, v53, v19 quad_perm:[3,3,3,3] row_mask:0xf bank_mask:0xf
  v_mfma_f32_16x16x32_bf16 v[20:23], v[228:231], v[84:87], v[20:23]
  v_and_b32_dpp v228, v54, v16 quad_perm:[3,3,3,3] row_mask:0xf bank_mask:0xf
  v_and_b32_dpp v229, v54, v17 quad_perm:[3,3,3,3] row_mask:0xf bank_mask:0xf
  v_and_b32_dpp v230, v55, v18 quad_perm:[3,3,3,3] row_mask:0xf bank_mask:0xf
  v_and_b32_dpp v231, v55, v19 quad_perm:[3,3,3,3] row_mask:0xf bank_mask:0xf
  v_mfma_f32_16x16x32_bf16 v[20:23], v[224:227], v[88:91], v[20:23]
  v_and_b32_dpp v224, v53, v16 quad_perm:[0,0,0,0] row_mask:0xf bank_mask:0xf
  v_and_b32_dpp v225, v53, v17 quad_perm:[0,0,0,0] row_mask:0xf bank_mask:0xf
  v_and_b32_dpp v226, v52, v18 quad_perm:[0,0,0,0] row_mask:0xf bank_mask:0xf
  v_and_b32_dpp v227, v52, v19 quad_perm:[0,0,0,0] row_mask:0xf bank_mask:0xf
  v_mfma_f32_16x16x32_bf16 v[20:23], v[228:231], v[92:95], v[20:23]
  v_and_b32_dpp v228, v55, v16 quad_perm:[0,0,0,0] row_mask:0xf bank_mask:0xf
  v_and_b32_dpp v229, v55, v17 quad_perm:[0,0,0,0] row_mask:0xf bank_mask:0xf
  v_and_b32_dpp v230, v54, v18 quad_perm:[0,0,0,0] row_mask:0xf bank_mask:0xf
  v_and_b32_dpp v231, v54, v19 quad_perm:[0,0,0,0] row_mask:0xf bank_mask:0xf
  v_mfma_f32_16x16x32_bf16 v[20:23], v[224:227], v[96:99], v[20:23]
  v_and_b32_dpp v224, v53, v16 quad_perm:[1,1,1,1] row_mask:0xf bank_mask:0xf
  v_and_b32_dpp v225, v53, v17 quad_perm:[1,1,1,1] row_mask:0xf bank_mask:0xf
  v_and_b32_dpp v226, v52, v18 quad_perm:[1,1,1,1] row_mask:0xf bank_mask:0xf
  v_and_b32_dpp v227, v52, v19 quad_perm:[1,1,1,1] row_mask:0xf bank_mask:0xf
  v_mfma_f32_16x16x32_bf16 v[20:23], v[228:231], v[100:103], v[20:23]
  v_and_b32_dpp v228, v55, v16 quad_perm:[1,1,1,1] row_mask:0xf bank_mask:0xf
  v_and_b32_dpp v229, v55, v17 quad_perm:[1,1,1,1] row_mask:0xf bank_mask:0xf
  v_and_b32_dpp v230, v54, v18 quad_perm:[1,1,1,1] row_mask:0xf bank_mask:0xf
  v_and_b32_dpp v231, v54, v19 quad_perm:[1,1,1,1] row_mask:0xf bank_mask:0xf
  v_mfma_f32_16x16x32_bf16 v[20:23], v[224:227], v[104:107], v[20:23]
  v_and_b32_dpp v224, v53, v16 quad_perm:[2,2,2,2] row_mask:0xf bank_mask:0xf
  v_and_b32_dpp v225, v53, v17 quad_perm:[2,2,2,2] row_mask:0xf bank_mask:0xf
  v_and_b32_dpp v226, v52, v18 quad_perm:[2,2,2,2] row_mask:0xf bank_mask:0xf
  v_and_b32_dpp v227, v52, v19 quad_perm:[2,2,2,2] row_mask:0xf bank_mask:0xf
  v_mfma_f32_16x16x32_bf16 v[20:23], v[228:231], v[108:111], v[20:23]
  v_and_b32_dpp v228, v55, v16 quad_perm:[2,2,2,2] row_mask:0xf bank_mask:0xf
  v_and_b32_dpp v229, v55, v17 quad_perm:[2,2,2,2] row_mask:0xf bank_mask:0xf
  v_and_b32_dpp v230, v54, v18 quad_perm:[2,2,2,2] row_mask:0xf bank_mask:0xf
  v_and_b32_dpp v231, v54, v19 quad_perm:[2,2,2,2] row_mask:0xf bank_mask:0xf
  v_mfma_f32_16x16x32_bf16 v[20:23], v[224:227], v[112:115], v[20:23]
  v_and_b32_dpp v224, v53, v16 quad_perm:[3,3,3,3] row_mask:0xf bank_mask:0xf
  v_and_b32_dpp v225, v53, v17 quad_perm:[3,3,3,3] row_mask:0xf bank_mask:0xf
  v_and_b32_dpp v226, v52, v18 quad_perm:[3,3,3,3] row_mask:0xf bank_mask:0xf
  v_and_b32_dpp v227, v52, v19 quad_perm:[3,3,3,3] row_mask:0xf bank_mask:0xf
  v_mfma_f32_16x16x32_bf16 v[20:23], v[228:231], v[116:119], v[20:23]
  v_and_b32_dpp v228, v55, v16 quad_perm:[3,3,3,3] row_mask:0xf bank_mask:0xf
  v_and_b32_dpp v229, v55, v17 quad_perm:[3,3,3,3] row_mask:0xf bank_mask:0xf
  v_and_b32_dpp v230, v54, v18 quad_perm:[3,3,3,3] row_mask:0xf bank_mask:0xf
  v_and_b32_dpp v231, v54, v19 quad_perm:[3,3,3,3] row_mask:0xf bank_mask:0xf
  v_mfma_f32_16x16x32_bf16 v[20:23], v[224:227], v[120:123], v[20:23]
  s_nop 0
  v_mfma_f32_16x16x32_bf16 v[20:23], v[228:231], v[124:127], v[20:23]
  s_nop 7
  v_permlane32_swap_b32 v20, v22
  v_permlane32_swap_b32 v21, v23
  v_mov_b32 v8, v20
  v_mov_b32 v10, v21
  v_mov_b32 v12, v22
  v_mov_b32 v14, v23
  s_mov_b64 exec, s[78:79]
  buffer_store_dwordx4 v[8:11], v234, s[48:51], s73 offen sc1
  buffer_store_dwordx4 v[12:15], v234, s[48:51], s71 offen sc1
  s_mov_b64 exec, -1
  s_cmp_lt_u32 s8, 2
  s_cbranch_scc1 L_fin
L_pollC:
  buffer_load_dwordx4 v[28:31], v235, s[48:51], s80 offen sc1
  buffer_load_dwordx4 v[32:35], v235, s[48:51], s81 offen sc1
  buffer_load_dwordx4 v[36:39], v235, s[48:51], s82 offen sc1
  buffer_load_dwordx4 v[40:43], v236, s[48:51], s83 offen sc1
  s_waitcnt vmcnt(0)
  v_xor_b32 v44, s45, v29
  v_xor_b32 v45, s45, v31
  v_bitop3_b32 v44, v44, v33, s45 bitop3:0xf6
  v_bitop3_b32 v45, v45, v35, s45 bitop3:0xf6
  v_bitop3_b32 v44, v44, v37, s45 bitop3:0xf6
  v_bitop3_b32 v45, v45, v39, s45 bitop3:0xf6
  v_bitop3_b32 v44, v44, v41, s45 bitop3:0xf6
  v_bitop3_b32 v45, v45, v43, s45 bitop3:0xf6
  v_or_b32 v44, v44, v45
  v_cmp_ne_u32 vcc, 0, v44
  s_nop 0
  s_mov_b64 exec, vcc
  s_cbranch_execz L_gotC
  s_sub_u32 s84, s84, 1
  s_cbranch_scc1 L_fin
  s_branch L_pollC
L_gotC:
  s_mov_b64 exec, -1
  v_add_f32 v28, v28, v32
  v_add_f32 v30, v30, v34
  s_mov_b32 exec_hi, 0
  v_add_f32 v36, v36, v40
  v_add_f32 v38, v38, v42
  s_mov_b32 exec_hi, -1
  v_add_f32 v28, v28, v36
  v_add_f32 v30, v30, v38
  s_nop 0
  v_add_f32_dpp v28, v28, v28 row_ror:8 row_mask:0xf bank_mask:0xf
  v_add_f32_dpp v30, v30, v30 row_ror:8 row_mask:0xf bank_mask:0xf
  s_nop 1
  v_permlane16_swap_b32 v28, v30
  v_add_f32 v28, v28, v30
  v_mov_b32 v30, v28
  s_nop 1
  v_permlane32_swap_b32 v28, v30
  v_add_f32 v28, v28, v30
  v_mov_b32 v30, v28
  s_nop 1
  v_permlane16_swap_b32 v28, v30
  v_cvt_pk_bf16_f32 v29, v28, v30
  v_lshlrev_b32 v28, 16, v29
  v_and_b32 v30, s46, v29
  v_lshlrev_b32 v32, 16, v62
  v_and_b32 v33, s46, v62
  v_mul_f32 v28, v28, v32
  v_mul_f32 v30, v30, v33
  v_cvt_pk_bf16_f32 v29, v28, v30
  v_lshlrev_b32 v28, 16, v29
  v_and_b32 v30, s46, v29
  v_lshlrev_b32 v32, 16, v60
  v_and_b32 v33, s46, v60
  v_add_f32 v28, v28, v32
  v_add_f32 v30, v30, v33
  v_cvt_pk_bf16_f32 v28, v28, v30
  s_mov_b64 exec, 0xff
  global_store_dword v239, v28, s[38:39]
L_fin:
L_end:
  s_endpgm
L_codeend:
.fill (26624 - (L_codeend - L_start)) / 4, 4, 0xbf800000
.section .rodata,"a"
.p2align 6
.amdhsa_kernel adaLN_cond__sliding_block_cached__glu_gated_glu__decode_kernel
  .amdhsa_next_free_vgpr 256
  .amdhsa_next_free_sgpr 102
  .amdhsa_accum_offset 256
  .amdhsa_group_segment_fixed_size 0
  .amdhsa_kernarg_size 112
  .amdhsa_user_sgpr_count 2
  .amdhsa_user_sgpr_kernarg_segment_ptr 1
  .amdhsa_system_sgpr_workgroup_id_x 1
.end_amdhsa_kernel
```
